```python
import torch

def _softmax(x, axis=-1):
    return torch.softmax(x, dim=axis)

def _gelu(x):
    return torch.nn.functional.gelu(x, approximate='tanh')

def _silu(x):
    return torch.nn.functional.silu(x)

def _sigmoid(x):
    return torch.sigmoid(x)

def _layernorm(x, axis=-1, eps=1e-05):
    m = x.mean(dim=axis, keepdim=True)
    v = x.var(dim=axis, keepdim=True, unbiased=False)
    return (x - m) / torch.sqrt(v + eps)

def _scatter_add(tgt, idx, src, axis=0):
    return tgt.clone().index_add_(axis, idx, src)

def _segment_sum(src, seg, n):
    out = torch.zeros((n,) + src.shape[1:], dtype=src.dtype)
    return out.index_add_(0, seg, src)

def _pad(x, pw):
    flat = tuple((v for pair in reversed(pw) for v in pair))
    return torch.nn.functional.pad(x, flat)
kernel_name = 'standalone__autoregressive_conv_wavernn__speech'

def setup_inputs():

    _w = lambda a: (lambda t: t.to(torch.bfloat16) if t.is_floating_point() else t)(torch.as_tensor(a))
    B, T, D, K = (2, 4000, 512, 5)
    return {'x': _w((lambda *s: torch.randn(*s, dtype=torch.bfloat16) * 0.05)(B, T, D)), 'w': _w((lambda *s: torch.randn(*s, dtype=torch.bfloat16) * 0.05)(K, D, 2 * D))}

def reference(x, w):
    B, T, D = x.shape
    K = w.shape[0]
    dil = 2
    pad = (K - 1) * dil
    xp = _pad(x, ((0, 0), (pad, 0), (0, 0)))
    h = torch.einsum('btd,de->bte', xp[:, 0:T, :], w[0])
    for i in range(1, K):
        h = h + torch.einsum('btd,de->bte', xp[:, i * dil:i * dil + T, :], w[i])
    f, g = (h[..., :D].clone(), h[..., D:].clone())
    return torch.tanh(f) * _sigmoid(g)
```

```asm
; @launch grid=(256,1,1) block=(512,1,1) lds=149504
.amdgcn_target "amdgcn-amd-amdhsa--gfx950"
.text
.globl standalone__autoregressive_conv_wavernn__speech_kernel
.p2align 8
.type standalone__autoregressive_conv_wavernn__speech_kernel,@function
standalone__autoregressive_conv_wavernn__speech_kernel:
s_cmp_ge_u32 s2, 256
s_cbranch_scc1 L_end
s_load_dwordx2 s[12:13], s[0:1], 0
s_load_dwordx2 s[16:17], s[0:1], 8
s_load_dwordx2 s[20:21], s[0:1], 16
v_lshrrev_b32 v1, 6, v0
v_bfrev_b32 v8, 1
v_and_b32 v0, 63, v0
s_and_b32 s28, s2, 7
v_readfirstlane_b32 s24, v1
s_lshr_b32 s29, s2, 3
s_lshr_b32 s30, s28, 1
s_lshl_b32 s30, s30, 3
s_lshr_b32 s31, s29, 2
s_add_u32 s30, s30, s31
s_and_b32 s31, s28, 1
s_lshl_b32 s31, s31, 2
s_and_b32 s29, s29, 3
s_add_u32 s31, s31, s29
s_lshr_b32 s27, s30, 4
s_and_b32 s25, s30, 15
s_lshl_b32 s25, s25, 8
s_lshl_b32 s26, s31, 6
s_mul_i32 s28, s27, 4096000
s_mov_b32 s14, 4096000
s_mov_b32 s15, 0x20000
s_mov_b32 s18, 5242880
s_mov_b32 s19, s15
s_mov_b32 s22, s14
s_mov_b32 s23, s15
s_movk_i32 s78, 0x1000
s_mov_b32 s79, 0x100000
s_movk_i32 s80, 0x800
s_and_b32 s34, s24, 3
s_lshl_b32 s38, s34, 10
s_cmp_lt_u32 s24, 4
s_cbranch_scc1 L_compute
s_setprio 3
v_lshrrev_b32 v10, 5, v0
v_bfe_u32 v11, v0, 2, 3
v_and_b32 v12, 3, v0
v_lshrrev_b32 v13, 2, v11
v_lshlrev_b32 v13, 1, v13
v_xor_b32 v13, v13, v12
v_lshlrev_b32 v14, 6, v10
v_lshl_add_u32 v15, v13, 4, v14
v_lshl_add_u32 v16, v12, 4, v14
v_and_b32 v13, 1, v11
v_lshrrev_b32 v17, 1, v11
v_lshl_add_u32 v13, v17, 4, v13
s_lshl_b32 s35, s34, 6
s_add_u32 s35, s35, s25
s_sub_u32 s35, s35, 8
v_add_u32 v13, s35, v13
v_lshlrev_b32 v17, 10, v13
v_add_u32 v17, v17, v15
v_add_u32 v3, 0x2000, v17
v_bfrev_b32 v18, 1
v_cmp_gt_i32 vcc, 0, v13
s_add_u32 s35, s25, 248
v_add_u32 v11, s35, v11
v_cndmask_b32 v2, v17, v18, vcc
v_lshlrev_b32 v11, 10, v11
v_add_u32 v4, v11, v16
s_lshl_b32 s35, s34, 4
s_mov_b64 s[36:37], 0xffff
s_lshl_b64 s[36:37], s[36:37], s35
v_lshrrev_b32 v10, 3, v0
v_and_b32 v11, 7, v0
v_lshrrev_b32 v12, 1, v11
v_bfe_u32 v13, v10, 1, 1
s_and_b32 s35, s34, 1
s_lshl_b32 s35, s35, 1
v_or_b32 v13, s35, v13
v_xor_b32 v12, v12, v13
v_lshlrev_b32 v12, 5, v12
v_and_b32 v11, 1, v11
v_lshl_add_u32 v12, v11, 4, v12
s_lshl_b32 s35, s34, 3
v_add_u32 v10, s35, v10
v_lshl_add_u32 v12, v10, 11, v12
s_lshl_b32 s35, s26, 1
v_add_u32 v1, s35, v12
s_mov_b32 s64, 0
s_mov_b32 s65, s38
s_mov_b32 s66, 0
s_add_u32 s67, s38, 81920
s_add_u32 s69, s38, 115712
s_xor_b32 s69, s69, s67
s_waitcnt lgkmcnt(0)
s_add_u32 s12, s12, s28
s_addc_u32 s13, s13, 0
s_mov_b32 m0, s65
s_mov_b32 s68, s64
buffer_load_dwordx4 v1, s[16:19], s68 offen lds
s_add_u32 m0, m0, s78
s_add_u32 s68, s68, s79
buffer_load_dwordx4 v1, s[16:19], s68 offen lds
s_add_u32 m0, m0, s78
s_add_u32 s68, s68, s79
buffer_load_dwordx4 v1, s[16:19], s68 offen lds
s_add_u32 m0, m0, s78
s_add_u32 s68, s68, s79
buffer_load_dwordx4 v1, s[16:19], s68 offen lds
s_add_u32 m0, m0, s78
s_add_u32 s68, s68, s79
buffer_load_dwordx4 v1, s[16:19], s68 offen lds
s_add_u32 s64, s64, 1024
s_add_u32 s65, s65, 20480
s_mov_b32 m0, s67
s_mov_b32 s68, s66
buffer_load_dwordx4 v2, s[12:15], s68 offen lds
s_add_u32 m0, m0, s78
s_add_u32 s68, s68, s80
buffer_load_dwordx4 v2, s[12:15], s68 offen lds
s_add_u32 m0, m0, s78
s_add_u32 s68, s68, s80
buffer_load_dwordx4 v2, s[12:15], s68 offen lds
s_add_u32 m0, m0, s78
s_add_u32 s68, s68, s80
buffer_load_dwordx4 v2, s[12:15], s68 offen lds
s_add_u32 m0, s67, 16384
s_mov_b32 s68, s66
buffer_load_dwordx4 v3, s[12:15], s68 offen lds
s_add_u32 m0, m0, s78
s_add_u32 s68, s68, s80
buffer_load_dwordx4 v3, s[12:15], s68 offen lds
s_add_u32 m0, m0, s78
s_add_u32 s68, s68, s80
buffer_load_dwordx4 v3, s[12:15], s68 offen lds
s_add_u32 m0, m0, s78
s_add_u32 s68, s68, s80
buffer_load_dwordx4 v3, s[12:15], s68 offen lds
s_sub_u32 m0, s67, s38
s_add_u32 m0, m0, 32768
s_mov_b64 exec, s[36:37]
buffer_load_dwordx4 v4, s[12:15], s66 offen lds
s_mov_b64 exec, -1
s_add_u32 s66, s66, 128
s_xor_b32 s67, s67, s69
s_mov_b32 m0, s65
s_mov_b32 s68, s64
buffer_load_dwordx4 v1, s[16:19], s68 offen lds
s_add_u32 m0, m0, s78
s_add_u32 s68, s68, s79
buffer_load_dwordx4 v1, s[16:19], s68 offen lds
s_add_u32 m0, m0, s78
s_add_u32 s68, s68, s79
buffer_load_dwordx4 v1, s[16:19], s68 offen lds
s_add_u32 m0, m0, s78
s_add_u32 s68, s68, s79
buffer_load_dwordx4 v1, s[16:19], s68 offen lds
s_add_u32 m0, m0, s78
s_add_u32 s68, s68, s79
buffer_load_dwordx4 v1, s[16:19], s68 offen lds
s_add_u32 s64, s64, 64512
s_add_u32 s65, s65, 20480
s_waitcnt vmcnt(5)
s_barrier
s_mov_b32 m0, s65
s_mov_b32 s68, s64
buffer_load_dwordx4 v1, s[16:19], s68 offen lds
s_add_u32 m0, m0, s78
s_add_u32 s68, s68, s79
buffer_load_dwordx4 v1, s[16:19], s68 offen lds
s_add_u32 m0, m0, s78
s_add_u32 s68, s68, s79
buffer_load_dwordx4 v1, s[16:19], s68 offen lds
s_add_u32 m0, m0, s78
s_add_u32 s68, s68, s79
buffer_load_dwordx4 v1, s[16:19], s68 offen lds
s_add_u32 m0, m0, s78
s_add_u32 s68, s68, s79
buffer_load_dwordx4 v1, s[16:19], s68 offen lds
s_add_u32 s64, s64, 1024
s_add_u32 s65, s65, 20480
s_waitcnt vmcnt(5)
s_barrier
s_mov_b32 m0, s65
s_mov_b32 s68, s64
buffer_load_dwordx4 v1, s[16:19], s68 offen lds
s_add_u32 m0, m0, s78
s_add_u32 s68, s68, s79
buffer_load_dwordx4 v1, s[16:19], s68 offen lds
s_add_u32 m0, m0, s78
s_add_u32 s68, s68, s79
buffer_load_dwordx4 v1, s[16:19], s68 offen lds
s_add_u32 m0, m0, s78
s_add_u32 s68, s68, s79
buffer_load_dwordx4 v1, s[16:19], s68 offen lds
s_add_u32 m0, m0, s78
s_add_u32 s68, s68, s79
buffer_load_dwordx4 v1, s[16:19], s68 offen lds
s_add_u32 s64, s64, 64512
s_sub_u32 s65, s65, 61440
s_mov_b32 m0, s67
s_mov_b32 s68, s66
buffer_load_dwordx4 v2, s[12:15], s68 offen lds
s_add_u32 m0, m0, s78
s_add_u32 s68, s68, s80
buffer_load_dwordx4 v2, s[12:15], s68 offen lds
s_add_u32 m0, m0, s78
s_add_u32 s68, s68, s80
buffer_load_dwordx4 v2, s[12:15], s68 offen lds
s_add_u32 m0, m0, s78
s_add_u32 s68, s68, s80
buffer_load_dwordx4 v2, s[12:15], s68 offen lds
s_waitcnt vmcnt(9)
s_barrier
s_mov_b32 m0, s65
s_mov_b32 s68, s64
buffer_load_dwordx4 v1, s[16:19], s68 offen lds
s_add_u32 m0, m0, s78
s_add_u32 s68, s68, s79
buffer_load_dwordx4 v1, s[16:19], s68 offen lds
s_add_u32 m0, m0, s78
s_add_u32 s68, s68, s79
buffer_load_dwordx4 v1, s[16:19], s68 offen lds
s_add_u32 m0, m0, s78
s_add_u32 s68, s68, s79
buffer_load_dwordx4 v1, s[16:19], s68 offen lds
s_add_u32 m0, m0, s78
s_add_u32 s68, s68, s79
buffer_load_dwordx4 v1, s[16:19], s68 offen lds
s_add_u32 s64, s64, 1024
s_add_u32 s65, s65, 20480
s_add_u32 m0, s67, 16384
s_mov_b32 s68, s66
buffer_load_dwordx4 v3, s[12:15], s68 offen lds
s_add_u32 m0, m0, s78
s_add_u32 s68, s68, s80
buffer_load_dwordx4 v3, s[12:15], s68 offen lds
s_add_u32 m0, m0, s78
s_add_u32 s68, s68, s80
buffer_load_dwordx4 v3, s[12:15], s68 offen lds
s_add_u32 m0, m0, s78
s_add_u32 s68, s68, s80
buffer_load_dwordx4 v3, s[12:15], s68 offen lds
s_sub_u32 m0, s67, s38
s_add_u32 m0, m0, 32768
s_mov_b64 exec, s[36:37]
buffer_load_dwordx4 v4, s[12:15], s66 offen lds
s_mov_b64 exec, -1
s_add_u32 s66, s66, 128
s_xor_b32 s67, s67, s69
s_waitcnt vmcnt(14)
s_barrier
s_mov_b32 m0, s65
s_mov_b32 s68, s64
buffer_load_dwordx4 v1, s[16:19], s68 offen lds
s_add_u32 m0, m0, s78
s_add_u32 s68, s68, s79
buffer_load_dwordx4 v1, s[16:19], s68 offen lds
s_add_u32 m0, m0, s78
s_add_u32 s68, s68, s79
buffer_load_dwordx4 v1, s[16:19], s68 offen lds
s_add_u32 m0, m0, s78
s_add_u32 s68, s68, s79
buffer_load_dwordx4 v1, s[16:19], s68 offen lds
s_add_u32 m0, m0, s78
s_add_u32 s68, s68, s79
buffer_load_dwordx4 v1, s[16:19], s68 offen lds
s_add_u32 s64, s64, 64512
s_add_u32 s65, s65, 20480
s_mov_b32 m0, s65
s_mov_b32 s68, s64
buffer_load_dwordx4 v1, s[16:19], s68 offen lds
s_add_u32 m0, m0, s78
s_add_u32 s68, s68, s79
buffer_load_dwordx4 v1, s[16:19], s68 offen lds
s_add_u32 m0, m0, s78
s_add_u32 s68, s68, s79
buffer_load_dwordx4 v1, s[16:19], s68 offen lds
s_add_u32 m0, m0, s78
s_add_u32 s68, s68, s79
buffer_load_dwordx4 v1, s[16:19], s68 offen lds
s_add_u32 m0, m0, s78
s_add_u32 s68, s68, s79
buffer_load_dwordx4 v1, s[16:19], s68 offen lds
s_add_u32 s64, s64, 1024
s_add_u32 s65, s65, 20480
s_waitcnt vmcnt(10)
s_barrier
s_mov_b32 m0, s65
s_mov_b32 s68, s64
buffer_load_dwordx4 v1, s[16:19], s68 offen lds
s_add_u32 m0, m0, s78
s_add_u32 s68, s68, s79
buffer_load_dwordx4 v1, s[16:19], s68 offen lds
s_add_u32 m0, m0, s78
s_add_u32 s68, s68, s79
buffer_load_dwordx4 v1, s[16:19], s68 offen lds
s_add_u32 m0, m0, s78
s_add_u32 s68, s68, s79
buffer_load_dwordx4 v1, s[16:19], s68 offen lds
s_add_u32 m0, m0, s78
s_add_u32 s68, s68, s79
buffer_load_dwordx4 v1, s[16:19], s68 offen lds
s_add_u32 s64, s64, 64512
s_sub_u32 s65, s65, 61440
s_mov_b32 m0, s67
s_mov_b32 s68, s66
buffer_load_dwordx4 v2, s[12:15], s68 offen lds
s_add_u32 m0, m0, s78
s_add_u32 s68, s68, s80
buffer_load_dwordx4 v2, s[12:15], s68 offen lds
s_add_u32 m0, m0, s78
s_add_u32 s68, s68, s80
buffer_load_dwordx4 v2, s[12:15], s68 offen lds
s_add_u32 m0, m0, s78
s_add_u32 s68, s68, s80
buffer_load_dwordx4 v2, s[12:15], s68 offen lds
s_waitcnt vmcnt(14)
s_barrier
s_mov_b32 m0, s65
s_mov_b32 s68, s64
buffer_load_dwordx4 v1, s[16:19], s68 offen lds
s_add_u32 m0, m0, s78
s_add_u32 s68, s68, s79
buffer_load_dwordx4 v1, s[16:19], s68 offen lds
s_add_u32 m0, m0, s78
s_add_u32 s68, s68, s79
buffer_load_dwordx4 v1, s[16:19], s68 offen lds
s_add_u32 m0, m0, s78
s_add_u32 s68, s68, s79
buffer_load_dwordx4 v1, s[16:19], s68 offen lds
s_add_u32 m0, m0, s78
s_add_u32 s68, s68, s79
buffer_load_dwordx4 v1, s[16:19], s68 offen lds
s_add_u32 s64, s64, 1024
s_add_u32 s65, s65, 20480
s_add_u32 m0, s67, 16384
s_mov_b32 s68, s66
buffer_load_dwordx4 v3, s[12:15], s68 offen lds
s_add_u32 m0, m0, s78
s_add_u32 s68, s68, s80
buffer_load_dwordx4 v3, s[12:15], s68 offen lds
s_add_u32 m0, m0, s78
s_add_u32 s68, s68, s80
buffer_load_dwordx4 v3, s[12:15], s68 offen lds
s_add_u32 m0, m0, s78
s_add_u32 s68, s68, s80
buffer_load_dwordx4 v3, s[12:15], s68 offen lds
s_sub_u32 m0, s67, s38
s_add_u32 m0, m0, 32768
s_mov_b64 exec, s[36:37]
buffer_load_dwordx4 v4, s[12:15], s66 offen lds
s_mov_b64 exec, -1
s_add_u32 s66, s66, 128
s_xor_b32 s67, s67, s69
s_waitcnt vmcnt(19)
s_barrier
s_mov_b32 m0, s65
s_mov_b32 s68, s64
buffer_load_dwordx4 v1, s[16:19], s68 offen lds
s_add_u32 m0, m0, s78
s_add_u32 s68, s68, s79
buffer_load_dwordx4 v1, s[16:19], s68 offen lds
s_add_u32 m0, m0, s78
s_add_u32 s68, s68, s79
buffer_load_dwordx4 v1, s[16:19], s68 offen lds
s_add_u32 m0, m0, s78
s_add_u32 s68, s68, s79
buffer_load_dwordx4 v1, s[16:19], s68 offen lds
s_add_u32 m0, m0, s78
s_add_u32 s68, s68, s79
buffer_load_dwordx4 v1, s[16:19], s68 offen lds
s_add_u32 s64, s64, 64512
s_add_u32 s65, s65, 20480
s_mov_b32 s70, 0
L_lloop:
s_waitcnt vmcnt(15)
s_barrier
s_mov_b32 m0, s65
s_mov_b32 s68, s64
buffer_load_dwordx4 v1, s[16:19], s68 offen lds
s_add_u32 m0, m0, s78
s_add_u32 s68, s68, s79
buffer_load_dwordx4 v1, s[16:19], s68 offen lds
s_add_u32 m0, m0, s78
s_add_u32 s68, s68, s79
buffer_load_dwordx4 v1, s[16:19], s68 offen lds
s_add_u32 m0, m0, s78
s_add_u32 s68, s68, s79
buffer_load_dwordx4 v1, s[16:19], s68 offen lds
s_add_u32 m0, m0, s78
s_add_u32 s68, s68, s79
buffer_load_dwordx4 v1, s[16:19], s68 offen lds
s_add_u32 s64, s64, 1024
s_add_u32 s65, s65, 20480
s_mov_b32 m0, s67
s_mov_b32 s68, s66
buffer_load_dwordx4 v2, s[12:15], s68 offen lds
s_add_u32 m0, m0, s78
s_add_u32 s68, s68, s80
buffer_load_dwordx4 v2, s[12:15], s68 offen lds
s_add_u32 m0, m0, s78
s_add_u32 s68, s68, s80
buffer_load_dwordx4 v2, s[12:15], s68 offen lds
s_add_u32 m0, m0, s78
s_add_u32 s68, s68, s80
buffer_load_dwordx4 v2, s[12:15], s68 offen lds
s_waitcnt vmcnt(14)
s_barrier
s_mov_b32 m0, s65
s_mov_b32 s68, s64
buffer_load_dwordx4 v1, s[16:19], s68 offen lds
s_add_u32 m0, m0, s78
s_add_u32 s68, s68, s79
buffer_load_dwordx4 v1, s[16:19], s68 offen lds
s_add_u32 m0, m0, s78
s_add_u32 s68, s68, s79
buffer_load_dwordx4 v1, s[16:19], s68 offen lds
s_add_u32 m0, m0, s78
s_add_u32 s68, s68, s79
buffer_load_dwordx4 v1, s[16:19], s68 offen lds
s_add_u32 m0, m0, s78
s_add_u32 s68, s68, s79
buffer_load_dwordx4 v1, s[16:19], s68 offen lds
s_add_u32 s64, s64, 64512
s_sub_u32 s65, s65, 61440
s_add_u32 m0, s67, 16384
s_mov_b32 s68, s66
buffer_load_dwordx4 v3, s[12:15], s68 offen lds
s_add_u32 m0, m0, s78
s_add_u32 s68, s68, s80
buffer_load_dwordx4 v3, s[12:15], s68 offen lds
s_add_u32 m0, m0, s78
s_add_u32 s68, s68, s80
buffer_load_dwordx4 v3, s[12:15], s68 offen lds
s_add_u32 m0, m0, s78
s_add_u32 s68, s68, s80
buffer_load_dwordx4 v3, s[12:15], s68 offen lds
s_sub_u32 m0, s67, s38
s_add_u32 m0, m0, 32768
s_mov_b64 exec, s[36:37]
buffer_load_dwordx4 v4, s[12:15], s66 offen lds
s_mov_b64 exec, -1
s_add_u32 s66, s66, 128
s_xor_b32 s67, s67, s69
s_waitcnt vmcnt(19)
s_barrier
s_mov_b32 m0, s65
s_mov_b32 s68, s64
buffer_load_dwordx4 v1, s[16:19], s68 offen lds
s_add_u32 m0, m0, s78
s_add_u32 s68, s68, s79
buffer_load_dwordx4 v1, s[16:19], s68 offen lds
s_add_u32 m0, m0, s78
s_add_u32 s68, s68, s79
buffer_load_dwordx4 v1, s[16:19], s68 offen lds
s_add_u32 m0, m0, s78
s_add_u32 s68, s68, s79
buffer_load_dwordx4 v1, s[16:19], s68 offen lds
s_add_u32 m0, m0, s78
s_add_u32 s68, s68, s79
buffer_load_dwordx4 v1, s[16:19], s68 offen lds
s_add_u32 s64, s64, 1024
s_add_u32 s65, s65, 20480
s_waitcnt vmcnt(19)
s_barrier
s_mov_b32 m0, s65
s_mov_b32 s68, s64
buffer_load_dwordx4 v1, s[16:19], s68 offen lds
s_add_u32 m0, m0, s78
s_add_u32 s68, s68, s79
buffer_load_dwordx4 v1, s[16:19], s68 offen lds
s_add_u32 m0, m0, s78
s_add_u32 s68, s68, s79
buffer_load_dwordx4 v1, s[16:19], s68 offen lds
s_add_u32 m0, m0, s78
s_add_u32 s68, s68, s79
buffer_load_dwordx4 v1, s[16:19], s68 offen lds
s_add_u32 m0, m0, s78
s_add_u32 s68, s68, s79
buffer_load_dwordx4 v1, s[16:19], s68 offen lds
s_add_u32 s64, s64, 64512
s_add_u32 s65, s65, 20480
s_add_u32 s70, s70, 1
s_cmp_lt_u32 s70, 5
s_cbranch_scc1 L_lloop
s_waitcnt vmcnt(15)
s_barrier
s_mov_b32 m0, s65
s_mov_b32 s68, s64
buffer_load_dwordx4 v1, s[16:19], s68 offen lds
s_add_u32 m0, m0, s78
s_add_u32 s68, s68, s79
buffer_load_dwordx4 v1, s[16:19], s68 offen lds
s_add_u32 m0, m0, s78
s_add_u32 s68, s68, s79
buffer_load_dwordx4 v1, s[16:19], s68 offen lds
s_add_u32 m0, m0, s78
s_add_u32 s68, s68, s79
buffer_load_dwordx4 v1, s[16:19], s68 offen lds
s_add_u32 m0, m0, s78
s_add_u32 s68, s68, s79
buffer_load_dwordx4 v1, s[16:19], s68 offen lds
s_add_u32 s64, s64, 1024
s_add_u32 s65, s65, 20480
s_cmp_eq_u32 0, 0
s_branch L_pad0
L_back0:
s_waitcnt vmcnt(10)
s_barrier
s_mov_b32 m0, s65
s_mov_b32 s68, s64
buffer_load_dwordx4 v1, s[16:19], s68 offen lds
s_add_u32 m0, m0, s78
s_add_u32 s68, s68, s79
buffer_load_dwordx4 v1, s[16:19], s68 offen lds
s_add_u32 m0, m0, s78
s_add_u32 s68, s68, s79
buffer_load_dwordx4 v1, s[16:19], s68 offen lds
s_add_u32 m0, m0, s78
s_add_u32 s68, s68, s79
buffer_load_dwordx4 v1, s[16:19], s68 offen lds
s_add_u32 m0, m0, s78
s_add_u32 s68, s68, s79
buffer_load_dwordx4 v1, s[16:19], s68 offen lds
s_add_u32 s64, s64, 64512
s_sub_u32 s65, s65, 61440
s_cmp_eq_u32 0, 0
s_branch L_pad1
L_back1:
s_waitcnt vmcnt(10)
s_barrier
s_waitcnt vmcnt(5)
s_barrier
s_waitcnt vmcnt(0)
s_barrier
L_end:
s_endpgm
.p2align 12
L_page0:
L_compute:
s_lshr_b32 s34, s24, 1
s_and_b32 s35, s24, 1
v_lshrrev_b32 v10, 4, v0
v_and_b32 v11, 15, v0
v_lshrrev_b32 v12, 2, v11
v_lshl_add_u32 v12, v10, 3, v12
v_lshlrev_b32 v12, 7, v12
v_and_b32 v13, 3, v11
v_lshl_add_u32 v12, v13, 3, v12
v_lshrrev_b32 v13, 3, v11
v_and_b32 v14, 1, v10
v_lshl_or_b32 v13, v14, 1, v13
s_lshl_b32 s36, s35, 1
s_add_u32 s37, s36, 0
v_xor_b32 v14, s37, v13
v_lshl_add_u32 v1, v14, 5, v12
s_add_u32 s37, s36, 1
v_xor_b32 v14, s37, v13
v_lshl_add_u32 v2, v14, 5, v12
s_lshl_b32 s36, s34, 4
v_add_u32 v13, s36, v11
v_lshrrev_b32 v15, 3, v13
v_lshlrev_b32 v15, 10, v15
v_and_b32 v16, 7, v13
v_lshl_add_u32 v15, v16, 6, v15
v_bfe_u32 v16, v13, 2, 1
v_lshlrev_b32 v16, 1, v16
v_xor_b32 v16, v16, v10
v_lshl_add_u32 v15, v16, 4, v15
v_add_u32 v3, 81920, v15
v_add_u32 v13, 2, v13
v_lshrrev_b32 v15, 3, v13
v_lshlrev_b32 v15, 10, v15
v_and_b32 v16, 7, v13
v_lshl_add_u32 v15, v16, 6, v15
v_bfe_u32 v16, v13, 2, 1
v_lshlrev_b32 v16, 1, v16
v_xor_b32 v16, v16, v10
v_lshl_add_u32 v15, v16, 4, v15
v_add_u32 v17, 81920, v15
v_and_b32 v16, 1, v13
v_lshlrev_b32 v16, 6, v16
v_lshl_add_u32 v16, v10, 4, v16
v_add_u32 v16, 114688, v16
v_cmp_le_u32 vcc, 32, v13
v_add_u32 v18, 4096, v17
v_add_u32 v19, 128, v16
v_cndmask_b32 v5, v18, v19, vcc
v_add_u32 v18, 8192, v17
v_add_u32 v19, 256, v16
v_cndmask_b32 v6, v18, v19, vcc
v_add_u32 v18, 12288, v17
v_add_u32 v19, 384, v16
v_cndmask_b32 v7, v18, v19, vcc
v_cndmask_b32 v4, v17, v16, vcc
v_mov_b32 v32, 0
v_mov_b32 v33, 0
v_mov_b32 v34, 0
v_mov_b32 v35, 0
s_nop 1
v_mfma_f32_32x32x16_bf16 v[40:55], v[32:35], v[32:35], 0
v_mfma_f32_32x32x16_bf16 v[56:71], v[32:35], v[32:35], 0
v_mfma_f32_32x32x16_bf16 v[72:87], v[32:35], v[32:35], 0
v_mfma_f32_32x32x16_bf16 v[88:103], v[32:35], v[32:35], 0
v_mfma_f32_32x32x16_bf16 v[104:119], v[32:35], v[32:35], 0
v_mfma_f32_32x32x16_bf16 v[120:135], v[32:35], v[32:35], 0
v_mfma_f32_32x32x16_bf16 v[136:151], v[32:35], v[32:35], 0
v_mfma_f32_32x32x16_bf16 v[152:167], v[32:35], v[32:35], 0
s_mov_b32 s30, 0
s_mov_b32 s32, 33792
v_add_u32 v30, 40960, v1
v_add_u32 v31, 40960, v2
s_waitcnt lgkmcnt(0)
s_barrier
ds_read_b64_tr_b16 a[48:49], v1 offset:0
ds_read_b128 a[0:3], v3 offset:0
ds_read_b64_tr_b16 a[50:51], v1 offset:512
ds_read_b64_tr_b16 a[52:53], v1 offset:4096
ds_read_b64_tr_b16 a[54:55], v1 offset:4608
ds_read_b64_tr_b16 a[56:57], v1 offset:8192
ds_read_b128 a[4:7], v3 offset:4096
ds_read_b64_tr_b16 a[58:59], v1 offset:8704
ds_read_b128 a[8:11], v3 offset:8192
ds_read_b64_tr_b16 a[60:61], v1 offset:12288
ds_read_b64_tr_b16 a[62:63], v1 offset:12800
ds_read_b64_tr_b16 a[64:65], v1 offset:16384
ds_read_b64_tr_b16 a[66:67], v1 offset:16896
ds_read_b128 a[12:15], v3 offset:12288
s_waitcnt lgkmcnt(8)
ds_read_b128 a[16:19], v3 offset:16384
ds_read_b128 a[20:23], v3 offset:20480
ds_read_b128 a[24:27], v3 offset:24576
ds_read_b128 a[44:47], v7 offset:0
ds_read_b128 a[40:43], v6 offset:0
ds_read_b128 a[36:39], v5 offset:0
s_waitcnt lgkmcnt(8)
ds_read_b128 a[32:35], v4 offset:0
ds_read_b128 a[28:31], v3 offset:28672
L_cloop:
s_waitcnt lgkmcnt(5)
v_mfma_f32_16x16x32_bf16 v[40:43], a[48:51], a[0:3], v[40:43]
ds_read_b64_tr_b16 a[68:69], v2 offset:0
v_mfma_f32_16x16x32_bf16 v[40:43], a[52:55], a[4:7], v[40:43]
v_mfma_f32_16x16x32_bf16 v[40:43], a[56:59], a[8:11], v[40:43]
ds_read_b64_tr_b16 a[70:71], v2 offset:512
v_mfma_f32_16x16x32_bf16 v[40:43], a[60:63], a[12:15], v[40:43]
v_mfma_f32_16x16x32_bf16 v[40:43], a[64:67], a[16:19], v[40:43]
ds_read_b64_tr_b16 a[72:73], v2 offset:4096
v_mfma_f32_16x16x32_bf16 v[56:59], a[64:67], a[20:23], v[56:59]
v_mfma_f32_16x16x32_bf16 v[56:59], a[60:63], a[16:19], v[56:59]
ds_read_b64_tr_b16 a[74:75], v2 offset:4608
v_mfma_f32_16x16x32_bf16 v[56:59], a[56:59], a[12:15], v[56:59]
v_mfma_f32_16x16x32_bf16 v[56:59], a[52:55], a[8:11], v[56:59]
ds_read_b64_tr_b16 a[76:77], v2 offset:8192
v_mfma_f32_16x16x32_bf16 v[56:59], a[48:51], a[4:7], v[56:59]
v_mfma_f32_16x16x32_bf16 v[72:75], a[48:51], a[8:11], v[72:75]
ds_read_b64_tr_b16 a[78:79], v2 offset:8704
v_mfma_f32_16x16x32_bf16 v[72:75], a[52:55], a[12:15], v[72:75]
v_mfma_f32_16x16x32_bf16 v[72:75], a[56:59], a[16:19], v[72:75]
ds_read_b64_tr_b16 a[80:81], v2 offset:12288
v_mfma_f32_16x16x32_bf16 v[72:75], a[60:63], a[20:23], v[72:75]
v_mfma_f32_16x16x32_bf16 v[72:75], a[64:67], a[24:27], v[72:75]
ds_read_b64_tr_b16 a[82:83], v2 offset:12800
s_waitcnt lgkmcnt(3)
v_mfma_f32_16x16x32_bf16 v[88:91], a[64:67], a[28:31], v[88:91]
v_mfma_f32_16x16x32_bf16 v[88:91], a[60:63], a[24:27], v[88:91]
ds_read_b64_tr_b16 a[84:85], v2 offset:16384
v_mfma_f32_16x16x32_bf16 v[88:91], a[56:59], a[20:23], v[88:91]
v_mfma_f32_16x16x32_bf16 v[88:91], a[52:55], a[16:19], v[88:91]
ds_read_b64_tr_b16 a[86:87], v2 offset:16896
v_mfma_f32_16x16x32_bf16 v[88:91], a[48:51], a[12:15], v[88:91]
v_mfma_f32_16x16x32_bf16 v[104:107], a[48:51], a[16:19], v[104:107]
v_mfma_f32_16x16x32_bf16 v[104:107], a[52:55], a[20:23], v[104:107]
v_mfma_f32_16x16x32_bf16 v[104:107], a[56:59], a[24:27], v[104:107]
v_mfma_f32_16x16x32_bf16 v[104:107], a[60:63], a[28:31], v[104:107]
v_mfma_f32_16x16x32_bf16 v[104:107], a[64:67], a[32:35], v[104:107]
v_mfma_f32_16x16x32_bf16 v[120:123], a[64:67], a[36:39], v[120:123]
v_mfma_f32_16x16x32_bf16 v[120:123], a[60:63], a[32:35], v[120:123]
v_mfma_f32_16x16x32_bf16 v[120:123], a[56:59], a[28:31], v[120:123]
v_mfma_f32_16x16x32_bf16 v[120:123], a[52:55], a[24:27], v[120:123]
v_mfma_f32_16x16x32_bf16 v[120:123], a[48:51], a[20:23], v[120:123]
v_mfma_f32_16x16x32_bf16 v[136:139], a[48:51], a[24:27], v[136:139]
v_mfma_f32_16x16x32_bf16 v[136:139], a[52:55], a[28:31], v[136:139]
v_mfma_f32_16x16x32_bf16 v[136:139], a[56:59], a[32:35], v[136:139]
v_mfma_f32_16x16x32_bf16 v[136:139], a[60:63], a[36:39], v[136:139]
v_mfma_f32_16x16x32_bf16 v[136:139], a[64:67], a[40:43], v[136:139]
v_mfma_f32_16x16x32_bf16 v[152:155], a[64:67], a[44:47], v[152:155]
v_mfma_f32_16x16x32_bf16 v[152:155], a[60:63], a[40:43], v[152:155]
v_mfma_f32_16x16x32_bf16 v[152:155], a[56:59], a[36:39], v[152:155]
v_mfma_f32_16x16x32_bf16 v[152:155], a[52:55], a[32:35], v[152:155]
v_mfma_f32_16x16x32_bf16 v[152:155], a[48:51], a[28:31], v[152:155]
s_waitcnt lgkmcnt(0)
s_barrier
v_mfma_f32_16x16x32_bf16 v[44:47], a[68:71], a[0:3], v[44:47]
ds_read_b64_tr_b16 a[48:49], v1 offset:20480
v_mfma_f32_16x16x32_bf16 v[44:47], a[72:75], a[4:7], v[44:47]
v_mfma_f32_16x16x32_bf16 v[44:47], a[76:79], a[8:11], v[44:47]
ds_read_b64_tr_b16 a[50:51], v1 offset:20992
v_mfma_f32_16x16x32_bf16 v[44:47], a[80:83], a[12:15], v[44:47]
v_mfma_f32_16x16x32_bf16 v[44:47], a[84:87], a[16:19], v[44:47]
ds_read_b64_tr_b16 a[52:53], v1 offset:24576
v_mfma_f32_16x16x32_bf16 v[60:63], a[84:87], a[20:23], v[60:63]
v_mfma_f32_16x16x32_bf16 v[60:63], a[80:83], a[16:19], v[60:63]
ds_read_b64_tr_b16 a[54:55], v1 offset:25088
v_mfma_f32_16x16x32_bf16 v[60:63], a[76:79], a[12:15], v[60:63]
v_mfma_f32_16x16x32_bf16 v[60:63], a[72:75], a[8:11], v[60:63]
ds_read_b64_tr_b16 a[56:57], v1 offset:28672
v_mfma_f32_16x16x32_bf16 v[60:63], a[68:71], a[4:7], v[60:63]
v_mfma_f32_16x16x32_bf16 v[76:79], a[68:71], a[8:11], v[76:79]
ds_read_b64_tr_b16 a[58:59], v1 offset:29184
v_mfma_f32_16x16x32_bf16 v[76:79], a[72:75], a[12:15], v[76:79]
v_mfma_f32_16x16x32_bf16 v[76:79], a[76:79], a[16:19], v[76:79]
ds_read_b64_tr_b16 a[60:61], v1 offset:32768
v_mfma_f32_16x16x32_bf16 v[76:79], a[80:83], a[20:23], v[76:79]
v_mfma_f32_16x16x32_bf16 v[76:79], a[84:87], a[24:27], v[76:79]
ds_read_b64_tr_b16 a[62:63], v1 offset:33280
v_mfma_f32_16x16x32_bf16 v[92:95], a[84:87], a[28:31], v[92:95]
v_mfma_f32_16x16x32_bf16 v[92:95], a[80:83], a[24:27], v[92:95]
ds_read_b64_tr_b16 a[64:65], v1 offset:36864
v_mfma_f32_16x16x32_bf16 v[92:95], a[76:79], a[20:23], v[92:95]
v_mfma_f32_16x16x32_bf16 v[92:95], a[72:75], a[16:19], v[92:95]
ds_read_b64_tr_b16 a[66:67], v1 offset:37376
v_mfma_f32_16x16x32_bf16 v[92:95], a[68:71], a[12:15], v[92:95]
v_mfma_f32_16x16x32_bf16 v[108:111], a[68:71], a[16:19], v[108:111]
v_mfma_f32_16x16x32_bf16 v[108:111], a[72:75], a[20:23], v[108:111]
v_mfma_f32_16x16x32_bf16 v[108:111], a[76:79], a[24:27], v[108:111]
v_mfma_f32_16x16x32_bf16 v[108:111], a[80:83], a[28:31], v[108:111]
v_mfma_f32_16x16x32_bf16 v[108:111], a[84:87], a[32:35], v[108:111]
v_mfma_f32_16x16x32_bf16 v[124:127], a[84:87], a[36:39], v[124:127]
v_mfma_f32_16x16x32_bf16 v[124:127], a[80:83], a[32:35], v[124:127]
v_mfma_f32_16x16x32_bf16 v[124:127], a[76:79], a[28:31], v[124:127]
v_mfma_f32_16x16x32_bf16 v[124:127], a[72:75], a[24:27], v[124:127]
v_mfma_f32_16x16x32_bf16 v[124:127], a[68:71], a[20:23], v[124:127]
v_mfma_f32_16x16x32_bf16 v[140:143], a[68:71], a[24:27], v[140:143]
v_mfma_f32_16x16x32_bf16 v[140:143], a[72:75], a[28:31], v[140:143]
v_mfma_f32_16x16x32_bf16 v[140:143], a[76:79], a[32:35], v[140:143]
v_mfma_f32_16x16x32_bf16 v[140:143], a[80:83], a[36:39], v[140:143]
v_mfma_f32_16x16x32_bf16 v[140:143], a[84:87], a[40:43], v[140:143]
v_mfma_f32_16x16x32_bf16 v[156:159], a[84:87], a[44:47], v[156:159]
v_mfma_f32_16x16x32_bf16 v[156:159], a[80:83], a[40:43], v[156:159]
v_mfma_f32_16x16x32_bf16 v[156:159], a[76:79], a[36:39], v[156:159]
v_mfma_f32_16x16x32_bf16 v[156:159], a[72:75], a[32:35], v[156:159]
v_mfma_f32_16x16x32_bf16 v[156:159], a[68:71], a[28:31], v[156:159]
s_waitcnt lgkmcnt(0)
v_mfma_f32_16x16x32_bf16 v[48:51], a[48:51], a[0:3], v[48:51]
ds_read_b64_tr_b16 a[68:69], v2 offset:20480
v_mfma_f32_16x16x32_bf16 v[48:51], a[52:55], a[4:7], v[48:51]
v_mfma_f32_16x16x32_bf16 v[48:51], a[56:59], a[8:11], v[48:51]
ds_read_b64_tr_b16 a[70:71], v2 offset:20992
v_mfma_f32_16x16x32_bf16 v[48:51], a[60:63], a[12:15], v[48:51]
v_mfma_f32_16x16x32_bf16 v[48:51], a[64:67], a[16:19], v[48:51]
ds_read_b64_tr_b16 a[72:73], v2 offset:24576
v_mfma_f32_16x16x32_bf16 v[64:67], a[64:67], a[20:23], v[64:67]
v_mfma_f32_16x16x32_bf16 v[64:67], a[60:63], a[16:19], v[64:67]
ds_read_b64_tr_b16 a[74:75], v2 offset:25088
v_mfma_f32_16x16x32_bf16 v[64:67], a[56:59], a[12:15], v[64:67]
v_mfma_f32_16x16x32_bf16 v[64:67], a[52:55], a[8:11], v[64:67]
ds_read_b64_tr_b16 a[76:77], v2 offset:28672
v_mfma_f32_16x16x32_bf16 v[64:67], a[48:51], a[4:7], v[64:67]
v_mfma_f32_16x16x32_bf16 v[80:83], a[48:51], a[8:11], v[80:83]
ds_read_b64_tr_b16 a[78:79], v2 offset:29184
v_mfma_f32_16x16x32_bf16 v[80:83], a[52:55], a[12:15], v[80:83]
v_mfma_f32_16x16x32_bf16 v[80:83], a[56:59], a[16:19], v[80:83]
ds_read_b64_tr_b16 a[80:81], v2 offset:32768
v_mfma_f32_16x16x32_bf16 v[80:83], a[60:63], a[20:23], v[80:83]
v_mfma_f32_16x16x32_bf16 v[80:83], a[64:67], a[24:27], v[80:83]
ds_read_b64_tr_b16 a[82:83], v2 offset:33280
v_mfma_f32_16x16x32_bf16 v[96:99], a[64:67], a[28:31], v[96:99]
v_mfma_f32_16x16x32_bf16 v[96:99], a[60:63], a[24:27], v[96:99]
ds_read_b64_tr_b16 a[84:85], v2 offset:36864
v_mfma_f32_16x16x32_bf16 v[96:99], a[56:59], a[20:23], v[96:99]
v_mfma_f32_16x16x32_bf16 v[96:99], a[52:55], a[16:19], v[96:99]
ds_read_b64_tr_b16 a[86:87], v2 offset:37376
v_mfma_f32_16x16x32_bf16 v[96:99], a[48:51], a[12:15], v[96:99]
v_mfma_f32_16x16x32_bf16 v[112:115], a[48:51], a[16:19], v[112:115]
v_mfma_f32_16x16x32_bf16 v[112:115], a[52:55], a[20:23], v[112:115]
v_mfma_f32_16x16x32_bf16 v[112:115], a[56:59], a[24:27], v[112:115]
v_mfma_f32_16x16x32_bf16 v[112:115], a[60:63], a[28:31], v[112:115]
v_mfma_f32_16x16x32_bf16 v[112:115], a[64:67], a[32:35], v[112:115]
v_mfma_f32_16x16x32_bf16 v[128:131], a[64:67], a[36:39], v[128:131]
v_mfma_f32_16x16x32_bf16 v[128:131], a[60:63], a[32:35], v[128:131]
v_mfma_f32_16x16x32_bf16 v[128:131], a[56:59], a[28:31], v[128:131]
v_mfma_f32_16x16x32_bf16 v[128:131], a[52:55], a[24:27], v[128:131]
v_mfma_f32_16x16x32_bf16 v[128:131], a[48:51], a[20:23], v[128:131]
v_mfma_f32_16x16x32_bf16 v[144:147], a[48:51], a[24:27], v[144:147]
v_mfma_f32_16x16x32_bf16 v[144:147], a[52:55], a[28:31], v[144:147]
v_mfma_f32_16x16x32_bf16 v[144:147], a[56:59], a[32:35], v[144:147]
v_mfma_f32_16x16x32_bf16 v[144:147], a[60:63], a[36:39], v[144:147]
v_mfma_f32_16x16x32_bf16 v[144:147], a[64:67], a[40:43], v[144:147]
v_mfma_f32_16x16x32_bf16 v[160:163], a[64:67], a[44:47], v[160:163]
v_mfma_f32_16x16x32_bf16 v[160:163], a[60:63], a[40:43], v[160:163]
v_mfma_f32_16x16x32_bf16 v[160:163], a[56:59], a[36:39], v[160:163]
v_mfma_f32_16x16x32_bf16 v[160:163], a[52:55], a[32:35], v[160:163]
v_mfma_f32_16x16x32_bf16 v[160:163], a[48:51], a[28:31], v[160:163]
s_waitcnt lgkmcnt(0)
s_barrier
v_mfma_f32_16x16x32_bf16 v[52:55], a[68:71], a[0:3], v[52:55]
ds_read_b64_tr_b16 a[48:49], v30 offset:0
ds_read_b128 a[0:3], v3 offset:512
v_mfma_f32_16x16x32_bf16 v[52:55], a[72:75], a[4:7], v[52:55]
v_mfma_f32_16x16x32_bf16 v[52:55], a[76:79], a[8:11], v[52:55]
ds_read_b64_tr_b16 a[50:51], v30 offset:512
v_mfma_f32_16x16x32_bf16 v[52:55], a[80:83], a[12:15], v[52:55]
v_mfma_f32_16x16x32_bf16 v[52:55], a[84:87], a[16:19], v[52:55]
ds_read_b64_tr_b16 a[52:53], v30 offset:4096
v_mfma_f32_16x16x32_bf16 v[68:71], a[84:87], a[20:23], v[68:71]
v_mfma_f32_16x16x32_bf16 v[68:71], a[80:83], a[16:19], v[68:71]
ds_read_b64_tr_b16 a[54:55], v30 offset:4608
v_mfma_f32_16x16x32_bf16 v[68:71], a[76:79], a[12:15], v[68:71]
v_mfma_f32_16x16x32_bf16 v[68:71], a[72:75], a[8:11], v[68:71]
ds_read_b64_tr_b16 a[56:57], v30 offset:8192
v_mfma_f32_16x16x32_bf16 v[68:71], a[68:71], a[4:7], v[68:71]
ds_read_b128 a[4:7], v3 offset:4608
v_mfma_f32_16x16x32_bf16 v[84:87], a[68:71], a[8:11], v[84:87]
ds_read_b64_tr_b16 a[58:59], v30 offset:8704
ds_read_b128 a[8:11], v3 offset:8704
v_mfma_f32_16x16x32_bf16 v[84:87], a[72:75], a[12:15], v[84:87]
v_mfma_f32_16x16x32_bf16 v[84:87], a[76:79], a[16:19], v[84:87]
ds_read_b64_tr_b16 a[60:61], v30 offset:12288
v_mfma_f32_16x16x32_bf16 v[84:87], a[80:83], a[20:23], v[84:87]
v_mfma_f32_16x16x32_bf16 v[84:87], a[84:87], a[24:27], v[84:87]
ds_read_b64_tr_b16 a[62:63], v30 offset:12800
v_mfma_f32_16x16x32_bf16 v[100:103], a[84:87], a[28:31], v[100:103]
v_mfma_f32_16x16x32_bf16 v[100:103], a[80:83], a[24:27], v[100:103]
ds_read_b64_tr_b16 a[64:65], v30 offset:16384
v_mfma_f32_16x16x32_bf16 v[100:103], a[76:79], a[20:23], v[100:103]
v_mfma_f32_16x16x32_bf16 v[100:103], a[72:75], a[16:19], v[100:103]
ds_read_b64_tr_b16 a[66:67], v30 offset:16896
v_mfma_f32_16x16x32_bf16 v[100:103], a[68:71], a[12:15], v[100:103]
ds_read_b128 a[12:15], v3 offset:12800
v_mfma_f32_16x16x32_bf16 v[116:119], a[68:71], a[16:19], v[116:119]
ds_read_b128 a[16:19], v3 offset:16896
v_mfma_f32_16x16x32_bf16 v[116:119], a[72:75], a[20:23], v[116:119]
v_mfma_f32_16x16x32_bf16 v[116:119], a[76:79], a[24:27], v[116:119]
v_mfma_f32_16x16x32_bf16 v[116:119], a[80:83], a[28:31], v[116:119]
v_mfma_f32_16x16x32_bf16 v[116:119], a[84:87], a[32:35], v[116:119]
v_mfma_f32_16x16x32_bf16 v[132:135], a[84:87], a[36:39], v[132:135]
v_mfma_f32_16x16x32_bf16 v[132:135], a[80:83], a[32:35], v[132:135]
v_mfma_f32_16x16x32_bf16 v[132:135], a[76:79], a[28:31], v[132:135]
v_mfma_f32_16x16x32_bf16 v[132:135], a[72:75], a[24:27], v[132:135]
v_mfma_f32_16x16x32_bf16 v[132:135], a[68:71], a[20:23], v[132:135]
ds_read_b128 a[20:23], v3 offset:20992
v_mfma_f32_16x16x32_bf16 v[148:151], a[68:71], a[24:27], v[148:151]
ds_read_b128 a[24:27], v3 offset:25088
v_mfma_f32_16x16x32_bf16 v[148:151], a[72:75], a[28:31], v[148:151]
v_mfma_f32_16x16x32_bf16 v[148:151], a[76:79], a[32:35], v[148:151]
v_mfma_f32_16x16x32_bf16 v[148:151], a[80:83], a[36:39], v[148:151]
v_mfma_f32_16x16x32_bf16 v[148:151], a[84:87], a[40:43], v[148:151]
v_mfma_f32_16x16x32_bf16 v[164:167], a[84:87], a[44:47], v[164:167]
ds_read_b128 a[44:47], v7 offset:512
v_mfma_f32_16x16x32_bf16 v[164:167], a[80:83], a[40:43], v[164:167]
ds_read_b128 a[40:43], v6 offset:512
v_mfma_f32_16x16x32_bf16 v[164:167], a[76:79], a[36:39], v[164:167]
ds_read_b128 a[36:39], v5 offset:512
v_mfma_f32_16x16x32_bf16 v[164:167], a[72:75], a[32:35], v[164:167]
ds_read_b128 a[32:35], v4 offset:512
v_mfma_f32_16x16x32_bf16 v[164:167], a[68:71], a[28:31], v[164:167]
ds_read_b128 a[28:31], v3 offset:29184
s_waitcnt lgkmcnt(5)
v_mfma_f32_16x16x32_bf16 v[40:43], a[48:51], a[0:3], v[40:43]
ds_read_b64_tr_b16 a[68:69], v31 offset:0
v_mfma_f32_16x16x32_bf16 v[40:43], a[52:55], a[4:7], v[40:43]
v_mfma_f32_16x16x32_bf16 v[40:43], a[56:59], a[8:11], v[40:43]
ds_read_b64_tr_b16 a[70:71], v31 offset:512
v_mfma_f32_16x16x32_bf16 v[40:43], a[60:63], a[12:15], v[40:43]
v_mfma_f32_16x16x32_bf16 v[40:43], a[64:67], a[16:19], v[40:43]
ds_read_b64_tr_b16 a[72:73], v31 offset:4096
v_mfma_f32_16x16x32_bf16 v[56:59], a[64:67], a[20:23], v[56:59]
v_mfma_f32_16x16x32_bf16 v[56:59], a[60:63], a[16:19], v[56:59]
ds_read_b64_tr_b16 a[74:75], v31 offset:4608
v_mfma_f32_16x16x32_bf16 v[56:59], a[56:59], a[12:15], v[56:59]
v_mfma_f32_16x16x32_bf16 v[56:59], a[52:55], a[8:11], v[56:59]
ds_read_b64_tr_b16 a[76:77], v31 offset:8192
v_mfma_f32_16x16x32_bf16 v[56:59], a[48:51], a[4:7], v[56:59]
v_mfma_f32_16x16x32_bf16 v[72:75], a[48:51], a[8:11], v[72:75]
ds_read_b64_tr_b16 a[78:79], v31 offset:8704
v_mfma_f32_16x16x32_bf16 v[72:75], a[52:55], a[12:15], v[72:75]
v_mfma_f32_16x16x32_bf16 v[72:75], a[56:59], a[16:19], v[72:75]
ds_read_b64_tr_b16 a[80:81], v31 offset:12288
v_mfma_f32_16x16x32_bf16 v[72:75], a[60:63], a[20:23], v[72:75]
v_mfma_f32_16x16x32_bf16 v[72:75], a[64:67], a[24:27], v[72:75]
ds_read_b64_tr_b16 a[82:83], v31 offset:12800
s_waitcnt lgkmcnt(3)
v_mfma_f32_16x16x32_bf16 v[88:91], a[64:67], a[28:31], v[88:91]
v_mfma_f32_16x16x32_bf16 v[88:91], a[60:63], a[24:27], v[88:91]
ds_read_b64_tr_b16 a[84:85], v31 offset:16384
v_mfma_f32_16x16x32_bf16 v[88:91], a[56:59], a[20:23], v[88:91]
v_mfma_f32_16x16x32_bf16 v[88:91], a[52:55], a[16:19], v[88:91]
ds_read_b64_tr_b16 a[86:87], v31 offset:16896
v_mfma_f32_16x16x32_bf16 v[88:91], a[48:51], a[12:15], v[88:91]
v_mfma_f32_16x16x32_bf16 v[104:107], a[48:51], a[16:19], v[104:107]
v_mfma_f32_16x16x32_bf16 v[104:107], a[52:55], a[20:23], v[104:107]
v_mfma_f32_16x16x32_bf16 v[104:107], a[56:59], a[24:27], v[104:107]
v_mfma_f32_16x16x32_bf16 v[104:107], a[60:63], a[28:31], v[104:107]
v_mfma_f32_16x16x32_bf16 v[104:107], a[64:67], a[32:35], v[104:107]
v_mfma_f32_16x16x32_bf16 v[120:123], a[64:67], a[36:39], v[120:123]
v_mfma_f32_16x16x32_bf16 v[120:123], a[60:63], a[32:35], v[120:123]
v_mfma_f32_16x16x32_bf16 v[120:123], a[56:59], a[28:31], v[120:123]
v_mfma_f32_16x16x32_bf16 v[120:123], a[52:55], a[24:27], v[120:123]
v_mfma_f32_16x16x32_bf16 v[120:123], a[48:51], a[20:23], v[120:123]
v_mfma_f32_16x16x32_bf16 v[136:139], a[48:51], a[24:27], v[136:139]
v_mfma_f32_16x16x32_bf16 v[136:139], a[52:55], a[28:31], v[136:139]
v_mfma_f32_16x16x32_bf16 v[136:139], a[56:59], a[32:35], v[136:139]
v_mfma_f32_16x16x32_bf16 v[136:139], a[60:63], a[36:39], v[136:139]
v_mfma_f32_16x16x32_bf16 v[136:139], a[64:67], a[40:43], v[136:139]
v_mfma_f32_16x16x32_bf16 v[152:155], a[64:67], a[44:47], v[152:155]
v_mfma_f32_16x16x32_bf16 v[152:155], a[60:63], a[40:43], v[152:155]
v_mfma_f32_16x16x32_bf16 v[152:155], a[56:59], a[36:39], v[152:155]
v_mfma_f32_16x16x32_bf16 v[152:155], a[52:55], a[32:35], v[152:155]
v_mfma_f32_16x16x32_bf16 v[152:155], a[48:51], a[28:31], v[152:155]
s_waitcnt lgkmcnt(0)
s_barrier
v_mfma_f32_16x16x32_bf16 v[44:47], a[68:71], a[0:3], v[44:47]
ds_read_b64_tr_b16 a[48:49], v30 offset:20480
v_mfma_f32_16x16x32_bf16 v[44:47], a[72:75], a[4:7], v[44:47]
v_mfma_f32_16x16x32_bf16 v[44:47], a[76:79], a[8:11], v[44:47]
ds_read_b64_tr_b16 a[50:51], v30 offset:20992
v_mfma_f32_16x16x32_bf16 v[44:47], a[80:83], a[12:15], v[44:47]
v_add_u32 v3, s32, v3
v_mfma_f32_16x16x32_bf16 v[44:47], a[84:87], a[16:19], v[44:47]
ds_read_b64_tr_b16 a[52:53], v30 offset:24576
v_mfma_f32_16x16x32_bf16 v[60:63], a[84:87], a[20:23], v[60:63]
v_mfma_f32_16x16x32_bf16 v[60:63], a[80:83], a[16:19], v[60:63]
ds_read_b64_tr_b16 a[54:55], v30 offset:25088
v_mfma_f32_16x16x32_bf16 v[60:63], a[76:79], a[12:15], v[60:63]
v_add_u32 v4, s32, v4
v_mfma_f32_16x16x32_bf16 v[60:63], a[72:75], a[8:11], v[60:63]
ds_read_b64_tr_b16 a[56:57], v30 offset:28672
v_mfma_f32_16x16x32_bf16 v[60:63], a[68:71], a[4:7], v[60:63]
v_mfma_f32_16x16x32_bf16 v[76:79], a[68:71], a[8:11], v[76:79]
ds_read_b64_tr_b16 a[58:59], v30 offset:29184
v_mfma_f32_16x16x32_bf16 v[76:79], a[72:75], a[12:15], v[76:79]
v_mfma_f32_16x16x32_bf16 v[76:79], a[76:79], a[16:19], v[76:79]
ds_read_b64_tr_b16 a[60:61], v30 offset:32768
v_mfma_f32_16x16x32_bf16 v[76:79], a[80:83], a[20:23], v[76:79]
v_mfma_f32_16x16x32_bf16 v[76:79], a[84:87], a[24:27], v[76:79]
ds_read_b64_tr_b16 a[62:63], v30 offset:33280
v_mfma_f32_16x16x32_bf16 v[92:95], a[84:87], a[28:31], v[92:95]
v_mfma_f32_16x16x32_bf16 v[92:95], a[80:83], a[24:27], v[92:95]
ds_read_b64_tr_b16 a[64:65], v30 offset:36864
v_mfma_f32_16x16x32_bf16 v[92:95], a[76:79], a[20:23], v[92:95]
v_mfma_f32_16x16x32_bf16 v[92:95], a[72:75], a[16:19], v[92:95]
ds_read_b64_tr_b16 a[66:67], v30 offset:37376
v_mfma_f32_16x16x32_bf16 v[92:95], a[68:71], a[12:15], v[92:95]
v_mfma_f32_16x16x32_bf16 v[108:111], a[68:71], a[16:19], v[108:111]
v_mfma_f32_16x16x32_bf16 v[108:111], a[72:75], a[20:23], v[108:111]
v_mfma_f32_16x16x32_bf16 v[108:111], a[76:79], a[24:27], v[108:111]
v_mfma_f32_16x16x32_bf16 v[108:111], a[80:83], a[28:31], v[108:111]
v_add_u32 v5, s32, v5
v_mfma_f32_16x16x32_bf16 v[108:111], a[84:87], a[32:35], v[108:111]
v_mfma_f32_16x16x32_bf16 v[124:127], a[84:87], a[36:39], v[124:127]
v_mfma_f32_16x16x32_bf16 v[124:127], a[80:83], a[32:35], v[124:127]
v_mfma_f32_16x16x32_bf16 v[124:127], a[76:79], a[28:31], v[124:127]
v_add_u32 v6, s32, v6
v_mfma_f32_16x16x32_bf16 v[124:127], a[72:75], a[24:27], v[124:127]
v_mfma_f32_16x16x32_bf16 v[124:127], a[68:71], a[20:23], v[124:127]
v_mfma_f32_16x16x32_bf16 v[140:143], a[68:71], a[24:27], v[140:143]
v_mfma_f32_16x16x32_bf16 v[140:143], a[72:75], a[28:31], v[140:143]
v_add_u32 v7, s32, v7
v_mfma_f32_16x16x32_bf16 v[140:143], a[76:79], a[32:35], v[140:143]
v_mfma_f32_16x16x32_bf16 v[140:143], a[80:83], a[36:39], v[140:143]
v_mfma_f32_16x16x32_bf16 v[140:143], a[84:87], a[40:43], v[140:143]
v_mfma_f32_16x16x32_bf16 v[156:159], a[84:87], a[44:47], v[156:159]
s_sub_u32 s32, 0, s32
v_mfma_f32_16x16x32_bf16 v[156:159], a[80:83], a[40:43], v[156:159]
v_mfma_f32_16x16x32_bf16 v[156:159], a[76:79], a[36:39], v[156:159]
v_mfma_f32_16x16x32_bf16 v[156:159], a[72:75], a[32:35], v[156:159]
v_mfma_f32_16x16x32_bf16 v[156:159], a[68:71], a[28:31], v[156:159]
s_waitcnt lgkmcnt(0)
v_mfma_f32_16x16x32_bf16 v[48:51], a[48:51], a[0:3], v[48:51]
ds_read_b64_tr_b16 a[68:69], v31 offset:20480
v_mfma_f32_16x16x32_bf16 v[48:51], a[52:55], a[4:7], v[48:51]
v_mfma_f32_16x16x32_bf16 v[48:51], a[56:59], a[8:11], v[48:51]
ds_read_b64_tr_b16 a[70:71], v31 offset:20992
v_mfma_f32_16x16x32_bf16 v[48:51], a[60:63], a[12:15], v[48:51]
v_mfma_f32_16x16x32_bf16 v[48:51], a[64:67], a[16:19], v[48:51]
ds_read_b64_tr_b16 a[72:73], v31 offset:24576
v_mfma_f32_16x16x32_bf16 v[64:67], a[64:67], a[20:23], v[64:67]
v_mfma_f32_16x16x32_bf16 v[64:67], a[60:63], a[16:19], v[64:67]
ds_read_b64_tr_b16 a[74:75], v31 offset:25088
v_mfma_f32_16x16x32_bf16 v[64:67], a[56:59], a[12:15], v[64:67]
v_mfma_f32_16x16x32_bf16 v[64:67], a[52:55], a[8:11], v[64:67]
ds_read_b64_tr_b16 a[76:77], v31 offset:28672
v_mfma_f32_16x16x32_bf16 v[64:67], a[48:51], a[4:7], v[64:67]
v_mfma_f32_16x16x32_bf16 v[80:83], a[48:51], a[8:11], v[80:83]
ds_read_b64_tr_b16 a[78:79], v31 offset:29184
v_mfma_f32_16x16x32_bf16 v[80:83], a[52:55], a[12:15], v[80:83]
v_mfma_f32_16x16x32_bf16 v[80:83], a[56:59], a[16:19], v[80:83]
ds_read_b64_tr_b16 a[80:81], v31 offset:32768
v_mfma_f32_16x16x32_bf16 v[80:83], a[60:63], a[20:23], v[80:83]
v_mfma_f32_16x16x32_bf16 v[80:83], a[64:67], a[24:27], v[80:83]
ds_read_b64_tr_b16 a[82:83], v31 offset:33280
v_mfma_f32_16x16x32_bf16 v[96:99], a[64:67], a[28:31], v[96:99]
v_mfma_f32_16x16x32_bf16 v[96:99], a[60:63], a[24:27], v[96:99]
ds_read_b64_tr_b16 a[84:85], v31 offset:36864
v_mfma_f32_16x16x32_bf16 v[96:99], a[56:59], a[20:23], v[96:99]
v_mfma_f32_16x16x32_bf16 v[96:99], a[52:55], a[16:19], v[96:99]
ds_read_b64_tr_b16 a[86:87], v31 offset:37376
v_mfma_f32_16x16x32_bf16 v[96:99], a[48:51], a[12:15], v[96:99]
v_mfma_f32_16x16x32_bf16 v[112:115], a[48:51], a[16:19], v[112:115]
v_mfma_f32_16x16x32_bf16 v[112:115], a[52:55], a[20:23], v[112:115]
v_mfma_f32_16x16x32_bf16 v[112:115], a[56:59], a[24:27], v[112:115]
v_mfma_f32_16x16x32_bf16 v[112:115], a[60:63], a[28:31], v[112:115]
v_mfma_f32_16x16x32_bf16 v[112:115], a[64:67], a[32:35], v[112:115]
v_mfma_f32_16x16x32_bf16 v[128:131], a[64:67], a[36:39], v[128:131]
s_add_u32 s30, s30, 1
v_mfma_f32_16x16x32_bf16 v[128:131], a[60:63], a[32:35], v[128:131]
v_mfma_f32_16x16x32_bf16 v[128:131], a[56:59], a[28:31], v[128:131]
v_mfma_f32_16x16x32_bf16 v[128:131], a[52:55], a[24:27], v[128:131]
v_mfma_f32_16x16x32_bf16 v[128:131], a[48:51], a[20:23], v[128:131]
v_mfma_f32_16x16x32_bf16 v[144:147], a[48:51], a[24:27], v[144:147]
v_mfma_f32_16x16x32_bf16 v[144:147], a[52:55], a[28:31], v[144:147]
v_mfma_f32_16x16x32_bf16 v[144:147], a[56:59], a[32:35], v[144:147]
v_mfma_f32_16x16x32_bf16 v[144:147], a[60:63], a[36:39], v[144:147]
v_mfma_f32_16x16x32_bf16 v[144:147], a[64:67], a[40:43], v[144:147]
v_mfma_f32_16x16x32_bf16 v[160:163], a[64:67], a[44:47], v[160:163]
v_mfma_f32_16x16x32_bf16 v[160:163], a[60:63], a[40:43], v[160:163]
v_mfma_f32_16x16x32_bf16 v[160:163], a[56:59], a[36:39], v[160:163]
v_mfma_f32_16x16x32_bf16 v[160:163], a[52:55], a[32:35], v[160:163]
v_mfma_f32_16x16x32_bf16 v[160:163], a[48:51], a[28:31], v[160:163]
s_waitcnt lgkmcnt(0)
s_barrier
v_mfma_f32_16x16x32_bf16 v[52:55], a[68:71], a[0:3], v[52:55]
ds_read_b64_tr_b16 a[48:49], v1 offset:0
ds_read_b128 a[0:3], v3 offset:0
v_mfma_f32_16x16x32_bf16 v[52:55], a[72:75], a[4:7], v[52:55]
v_mfma_f32_16x16x32_bf16 v[52:55], a[76:79], a[8:11], v[52:55]
ds_read_b64_tr_b16 a[50:51], v1 offset:512
v_mfma_f32_16x16x32_bf16 v[52:55], a[80:83], a[12:15], v[52:55]
v_mfma_f32_16x16x32_bf16 v[52:55], a[84:87], a[16:19], v[52:55]
ds_read_b64_tr_b16 a[52:53], v1 offset:4096
v_mfma_f32_16x16x32_bf16 v[68:71], a[84:87], a[20:23], v[68:71]
v_mfma_f32_16x16x32_bf16 v[68:71], a[80:83], a[16:19], v[68:71]
ds_read_b64_tr_b16 a[54:55], v1 offset:4608
v_mfma_f32_16x16x32_bf16 v[68:71], a[76:79], a[12:15], v[68:71]
v_mfma_f32_16x16x32_bf16 v[68:71], a[72:75], a[8:11], v[68:71]
ds_read_b64_tr_b16 a[56:57], v1 offset:8192
v_mfma_f32_16x16x32_bf16 v[68:71], a[68:71], a[4:7], v[68:71]
ds_read_b128 a[4:7], v3 offset:4096
v_mfma_f32_16x16x32_bf16 v[84:87], a[68:71], a[8:11], v[84:87]
ds_read_b64_tr_b16 a[58:59], v1 offset:8704
ds_read_b128 a[8:11], v3 offset:8192
v_mfma_f32_16x16x32_bf16 v[84:87], a[72:75], a[12:15], v[84:87]
v_mfma_f32_16x16x32_bf16 v[84:87], a[76:79], a[16:19], v[84:87]
ds_read_b64_tr_b16 a[60:61], v1 offset:12288
v_mfma_f32_16x16x32_bf16 v[84:87], a[80:83], a[20:23], v[84:87]
v_mfma_f32_16x16x32_bf16 v[84:87], a[84:87], a[24:27], v[84:87]
ds_read_b64_tr_b16 a[62:63], v1 offset:12800
v_mfma_f32_16x16x32_bf16 v[100:103], a[84:87], a[28:31], v[100:103]
v_mfma_f32_16x16x32_bf16 v[100:103], a[80:83], a[24:27], v[100:103]
ds_read_b64_tr_b16 a[64:65], v1 offset:16384
v_mfma_f32_16x16x32_bf16 v[100:103], a[76:79], a[20:23], v[100:103]
v_mfma_f32_16x16x32_bf16 v[100:103], a[72:75], a[16:19], v[100:103]
ds_read_b64_tr_b16 a[66:67], v1 offset:16896
v_mfma_f32_16x16x32_bf16 v[100:103], a[68:71], a[12:15], v[100:103]
ds_read_b128 a[12:15], v3 offset:12288
v_mfma_f32_16x16x32_bf16 v[116:119], a[68:71], a[16:19], v[116:119]
ds_read_b128 a[16:19], v3 offset:16384
v_mfma_f32_16x16x32_bf16 v[116:119], a[72:75], a[20:23], v[116:119]
v_mfma_f32_16x16x32_bf16 v[116:119], a[76:79], a[24:27], v[116:119]
v_mfma_f32_16x16x32_bf16 v[116:119], a[80:83], a[28:31], v[116:119]
v_mfma_f32_16x16x32_bf16 v[116:119], a[84:87], a[32:35], v[116:119]
v_mfma_f32_16x16x32_bf16 v[132:135], a[84:87], a[36:39], v[132:135]
v_mfma_f32_16x16x32_bf16 v[132:135], a[80:83], a[32:35], v[132:135]
v_mfma_f32_16x16x32_bf16 v[132:135], a[76:79], a[28:31], v[132:135]
v_mfma_f32_16x16x32_bf16 v[132:135], a[72:75], a[24:27], v[132:135]
v_mfma_f32_16x16x32_bf16 v[132:135], a[68:71], a[20:23], v[132:135]
ds_read_b128 a[20:23], v3 offset:20480
v_mfma_f32_16x16x32_bf16 v[148:151], a[68:71], a[24:27], v[148:151]
ds_read_b128 a[24:27], v3 offset:24576
v_mfma_f32_16x16x32_bf16 v[148:151], a[72:75], a[28:31], v[148:151]
v_mfma_f32_16x16x32_bf16 v[148:151], a[76:79], a[32:35], v[148:151]
v_mfma_f32_16x16x32_bf16 v[148:151], a[80:83], a[36:39], v[148:151]
s_cmp_lt_u32 s30, 7
v_mfma_f32_16x16x32_bf16 v[148:151], a[84:87], a[40:43], v[148:151]
v_mfma_f32_16x16x32_bf16 v[164:167], a[84:87], a[44:47], v[164:167]
ds_read_b128 a[44:47], v7 offset:0
v_mfma_f32_16x16x32_bf16 v[164:167], a[80:83], a[40:43], v[164:167]
ds_read_b128 a[40:43], v6 offset:0
v_mfma_f32_16x16x32_bf16 v[164:167], a[76:79], a[36:39], v[164:167]
ds_read_b128 a[36:39], v5 offset:0
v_mfma_f32_16x16x32_bf16 v[164:167], a[72:75], a[32:35], v[164:167]
ds_read_b128 a[32:35], v4 offset:0
v_mfma_f32_16x16x32_bf16 v[164:167], a[68:71], a[28:31], v[164:167]
ds_read_b128 a[28:31], v3 offset:28672
s_cbranch_scc1 L_cloop
L_final:
s_cmp_lg_u32 0, 0
L_pad0:
s_cbranch_scc1 L_back0
s_nop 0
s_waitcnt lgkmcnt(5)
v_mfma_f32_16x16x32_bf16 v[40:43], a[48:51], a[0:3], v[40:43]
ds_read_b64_tr_b16 a[68:69], v2 offset:0
ds_read_b128 a[28:31], v3 offset:512
v_mfma_f32_16x16x32_bf16 v[40:43], a[52:55], a[4:7], v[40:43]
ds_read_b64_tr_b16 a[70:71], v2 offset:512
ds_read_b128 a[32:35], v3 offset:4608
v_mfma_f32_16x16x32_bf16 v[40:43], a[56:59], a[8:11], v[40:43]
ds_read_b64_tr_b16 a[72:73], v2 offset:4096
ds_read_b128 a[36:39], v3 offset:8704
v_mfma_f32_16x16x32_bf16 v[40:43], a[60:63], a[12:15], v[40:43]
ds_read_b64_tr_b16 a[74:75], v2 offset:4608
ds_read_b128 a[40:43], v3 offset:12800
v_mfma_f32_16x16x32_bf16 v[40:43], a[64:67], a[16:19], v[40:43]
ds_read_b64_tr_b16 a[76:77], v2 offset:8192
ds_read_b128 a[44:47], v3 offset:16896
v_mfma_f32_16x16x32_bf16 v[56:59], a[64:67], a[20:23], v[56:59]
ds_read_b64_tr_b16 a[78:79], v2 offset:8704
v_mfma_f32_16x16x32_bf16 v[56:59], a[60:63], a[16:19], v[56:59]
ds_read_b64_tr_b16 a[80:81], v2 offset:12288
v_mfma_f32_16x16x32_bf16 v[56:59], a[56:59], a[12:15], v[56:59]
ds_read_b64_tr_b16 a[82:83], v2 offset:12800
v_mfma_f32_16x16x32_bf16 v[56:59], a[52:55], a[8:11], v[56:59]
ds_read_b64_tr_b16 a[84:85], v2 offset:16384
v_bfe_u32 v13, v11, 1, 2
v_mfma_f32_16x16x32_bf16 v[56:59], a[48:51], a[4:7], v[56:59]
ds_read_b64_tr_b16 a[86:87], v2 offset:16896
v_lshrrev_b32 v14, 1, v10
v_mfma_f32_16x16x32_bf16 v[72:75], a[48:51], a[8:11], v[72:75]
v_xor_b32 v13, v13, v14
v_lshlrev_b32 v13, 4, v13
v_mfma_f32_16x16x32_bf16 v[72:75], a[52:55], a[12:15], v[72:75]
v_lshl_add_u32 v13, v11, 6, v13
v_and_b32 v14, 1, v10
v_mfma_f32_16x16x32_bf16 v[72:75], a[56:59], a[16:19], v[72:75]
v_lshl_add_u32 v13, v14, 3, v13
s_lshl_b32 s43, s24, 13
v_mfma_f32_16x16x32_bf16 v[72:75], a[60:63], a[20:23], v[72:75]
s_add_u32 s43, s43, 81920
v_add_u32 v28, s43, v13
v_mfma_f32_16x16x32_bf16 v[72:75], a[64:67], a[24:27], v[72:75]
v_xor_b32 v29, 32, v28
v_lshrrev_b32 v13, 2, v0
s_waitcnt lgkmcnt(0)
s_barrier
v_mfma_f32_16x16x32_bf16 v[44:47], a[68:71], a[0:3], v[44:47]
ds_read_b64_tr_b16 a[48:49], v1 offset:20480
v_mfma_f32_16x16x32_bf16 v[44:47], a[72:75], a[4:7], v[44:47]
ds_read_b64_tr_b16 a[50:51], v1 offset:20992
v_and_b32 v14, 3, v0
v_mfma_f32_16x16x32_bf16 v[44:47], a[76:79], a[8:11], v[44:47]
ds_read_b64_tr_b16 a[52:53], v1 offset:24576
v_bfe_u32 v15, v13, 1, 2
v_mfma_f32_16x16x32_bf16 v[44:47], a[80:83], a[12:15], v[44:47]
ds_read_b64_tr_b16 a[54:55], v1 offset:25088
v_xor_b32 v15, v15, v14
v_mfma_f32_16x16x32_bf16 v[44:47], a[84:87], a[16:19], v[44:47]
ds_read_b64_tr_b16 a[56:57], v1 offset:28672
v_lshlrev_b32 v15, 4, v15
v_mfma_f32_16x16x32_bf16 v[60:63], a[84:87], a[20:23], v[60:63]
ds_read_b64_tr_b16 a[58:59], v1 offset:29184
v_lshl_add_u32 v15, v13, 6, v15
v_mfma_f32_16x16x32_bf16 v[60:63], a[80:83], a[16:19], v[60:63]
ds_read_b64_tr_b16 a[60:61], v1 offset:32768
v_add_u32 v18, s43, v15
v_mfma_f32_16x16x32_bf16 v[60:63], a[76:79], a[12:15], v[60:63]
ds_read_b64_tr_b16 a[62:63], v1 offset:33280
v_and_b32 v15, 1, v13
v_mfma_f32_16x16x32_bf16 v[60:63], a[72:75], a[8:11], v[60:63]
ds_read_b64_tr_b16 a[64:65], v1 offset:36864
v_lshrrev_b32 v16, 1, v13
v_mfma_f32_16x16x32_bf16 v[60:63], a[68:71], a[4:7], v[60:63]
ds_read_b64_tr_b16 a[66:67], v1 offset:37376
v_lshl_add_u32 v15, v16, 4, v15
v_mfma_f32_16x16x32_bf16 v[76:79], a[68:71], a[8:11], v[76:79]
s_lshl_b32 s43, s34, 7
s_add_u32 s43, s43, s25
v_mfma_f32_16x16x32_bf16 v[76:79], a[72:75], a[12:15], v[76:79]
v_add_u32 v15, s43, v15
v_lshlrev_b32 v15, 10, v15
v_mfma_f32_16x16x32_bf16 v[76:79], a[76:79], a[16:19], v[76:79]
v_lshl_add_u32 v15, v14, 4, v15
s_lshl_b32 s43, s35, 5
v_mfma_f32_16x16x32_bf16 v[76:79], a[80:83], a[20:23], v[76:79]
s_add_u32 s43, s43, s26
s_lshl_b32 s43, s43, 1
v_mfma_f32_16x16x32_bf16 v[76:79], a[84:87], a[24:27], v[76:79]
v_add_u32 v8, s43, v15
s_add_u32 s20, s20, s28
s_waitcnt lgkmcnt(0)
v_mfma_f32_16x16x32_bf16 v[48:51], a[48:51], a[0:3], v[48:51]
ds_read_b64_tr_b16 a[68:69], v2 offset:20480
s_addc_u32 s21, s21, 0
v_mfma_f32_16x16x32_bf16 v[48:51], a[52:55], a[4:7], v[48:51]
ds_read_b64_tr_b16 a[70:71], v2 offset:20992
s_mov_b32 s36, 0x4038aa3b
v_mfma_f32_16x16x32_bf16 v[48:51], a[56:59], a[8:11], v[48:51]
ds_read_b64_tr_b16 a[72:73], v2 offset:24576
s_mov_b32 s37, 0x4038aa3b
v_mfma_f32_16x16x32_bf16 v[48:51], a[60:63], a[12:15], v[48:51]
ds_read_b64_tr_b16 a[74:75], v2 offset:25088
s_mov_b32 s38, 0xbfb8aa3b
v_mfma_f32_16x16x32_bf16 v[48:51], a[64:67], a[16:19], v[48:51]
ds_read_b64_tr_b16 a[76:77], v2 offset:28672
s_mov_b32 s39, 0xbfb8aa3b
v_mfma_f32_16x16x32_bf16 v[64:67], a[64:67], a[20:23], v[64:67]
ds_read_b64_tr_b16 a[78:79], v2 offset:29184
s_mov_b32 s42, 0x7fffffff
v_mfma_f32_16x16x32_bf16 v[64:67], a[60:63], a[16:19], v[64:67]
ds_read_b64_tr_b16 a[80:81], v2 offset:32768
s_cmp_lg_u32 0, 0
v_mfma_f32_16x16x32_bf16 v[64:67], a[56:59], a[12:15], v[64:67]
ds_read_b64_tr_b16 a[82:83], v2 offset:33280
v_mfma_f32_16x16x32_bf16 v[64:67], a[52:55], a[8:11], v[64:67]
ds_read_b64_tr_b16 a[84:85], v2 offset:36864
v_mfma_f32_16x16x32_bf16 v[64:67], a[48:51], a[4:7], v[64:67]
ds_read_b64_tr_b16 a[86:87], v2 offset:37376
v_mfma_f32_16x16x32_bf16 v[80:83], a[48:51], a[8:11], v[80:83]
v_mfma_f32_16x16x32_bf16 v[80:83], a[52:55], a[12:15], v[80:83]
v_mfma_f32_16x16x32_bf16 v[80:83], a[56:59], a[16:19], v[80:83]
v_mfma_f32_16x16x32_bf16 v[80:83], a[60:63], a[20:23], v[80:83]
v_mfma_f32_16x16x32_bf16 v[80:83], a[64:67], a[24:27], v[80:83]
s_waitcnt lgkmcnt(0)
s_barrier
v_mfma_f32_16x16x32_bf16 v[52:55], a[68:71], a[0:3], v[52:55]
ds_read_b64_tr_b16 a[48:49], v30 offset:0
ds_read_b128 a[0:3], v3 offset:20992
v_mfma_f32_16x16x32_bf16 v[52:55], a[72:75], a[4:7], v[52:55]
ds_read_b64_tr_b16 a[50:51], v30 offset:512
v_mfma_f32_16x16x32_bf16 v[52:55], a[76:79], a[8:11], v[52:55]
ds_read_b64_tr_b16 a[52:53], v30 offset:4096
v_mfma_f32_16x16x32_bf16 v[52:55], a[80:83], a[12:15], v[52:55]
ds_read_b64_tr_b16 a[54:55], v30 offset:4608
v_mfma_f32_16x16x32_bf16 v[52:55], a[84:87], a[16:19], v[52:55]
ds_read_b64_tr_b16 a[56:57], v30 offset:8192
v_mfma_f32_16x16x32_bf16 v[68:71], a[84:87], a[20:23], v[68:71]
ds_read_b64_tr_b16 a[58:59], v30 offset:8704
v_mfma_f32_16x16x32_bf16 v[68:71], a[80:83], a[16:19], v[68:71]
ds_read_b64_tr_b16 a[60:61], v30 offset:12288
v_mfma_f32_16x16x32_bf16 v[68:71], a[76:79], a[12:15], v[68:71]
ds_read_b64_tr_b16 a[62:63], v30 offset:12800
v_mfma_f32_16x16x32_bf16 v[68:71], a[72:75], a[8:11], v[68:71]
ds_read_b64_tr_b16 a[64:65], v30 offset:16384
v_mfma_f32_16x16x32_bf16 v[68:71], a[68:71], a[4:7], v[68:71]
ds_read_b64_tr_b16 a[66:67], v30 offset:16896
ds_read_b128 a[4:7], v3 offset:25088
v_mfma_f32_16x16x32_bf16 v[84:87], a[68:71], a[8:11], v[84:87]
v_mfma_f32_16x16x32_bf16 v[84:87], a[72:75], a[12:15], v[84:87]
v_mfma_f32_16x16x32_bf16 v[84:87], a[76:79], a[16:19], v[84:87]
v_mfma_f32_16x16x32_bf16 v[84:87], a[80:83], a[20:23], v[84:87]
v_mfma_f32_16x16x32_bf16 v[84:87], a[84:87], a[24:27], v[84:87]
s_waitcnt lgkmcnt(0)
v_mfma_f32_16x16x32_bf16 v[40:43], a[48:51], a[28:31], v[40:43]
ds_read_b64_tr_b16 a[68:69], v31 offset:0
ds_read_b128 a[8:11], v3 offset:12288
v_mfma_f32_16x16x32_bf16 v[40:43], a[52:55], a[32:35], v[40:43]
ds_read_b64_tr_b16 a[70:71], v31 offset:512
ds_read_b128 a[12:15], v3 offset:16384
v_mfma_f32_16x16x32_bf16 v[40:43], a[56:59], a[36:39], v[40:43]
ds_read_b64_tr_b16 a[72:73], v31 offset:4096
ds_read_b128 a[16:19], v3 offset:20480
v_mfma_f32_16x16x32_bf16 v[40:43], a[60:63], a[40:43], v[40:43]
ds_read_b64_tr_b16 a[74:75], v31 offset:4608
ds_read_b128 a[20:23], v3 offset:24576
v_mfma_f32_16x16x32_bf16 v[40:43], a[64:67], a[44:47], v[40:43]
ds_read_b64_tr_b16 a[76:77], v31 offset:8192
ds_read_b128 a[24:27], v3 offset:28672
v_mfma_f32_16x16x32_bf16 v[56:59], a[64:67], a[0:3], v[56:59]
ds_read_b64_tr_b16 a[78:79], v31 offset:8704
v_mfma_f32_16x16x32_bf16 v[56:59], a[60:63], a[44:47], v[56:59]
ds_read_b64_tr_b16 a[80:81], v31 offset:12288
v_mfma_f32_16x16x32_bf16 v[56:59], a[56:59], a[40:43], v[56:59]
ds_read_b64_tr_b16 a[82:83], v31 offset:12800
v_mfma_f32_16x16x32_bf16 v[56:59], a[52:55], a[36:39], v[56:59]
ds_read_b64_tr_b16 a[84:85], v31 offset:16384
v_mfma_f32_16x16x32_bf16 v[56:59], a[48:51], a[32:35], v[56:59]
ds_read_b64_tr_b16 a[86:87], v31 offset:16896
v_mfma_f32_16x16x32_bf16 v[72:75], a[48:51], a[36:39], v[72:75]
v_mfma_f32_16x16x32_bf16 v[72:75], a[52:55], a[40:43], v[72:75]
v_mfma_f32_16x16x32_bf16 v[72:75], a[56:59], a[44:47], v[72:75]
v_mfma_f32_16x16x32_bf16 v[72:75], a[60:63], a[0:3], v[72:75]
v_mfma_f32_16x16x32_bf16 v[72:75], a[64:67], a[4:7], v[72:75]
s_waitcnt lgkmcnt(0)
s_barrier
v_mfma_f32_16x16x32_bf16 v[44:47], a[68:71], a[28:31], v[44:47]
ds_read_b64_tr_b16 a[48:49], v30 offset:20480
v_mfma_f32_16x16x32_bf16 v[44:47], a[72:75], a[32:35], v[44:47]
ds_read_b64_tr_b16 a[50:51], v30 offset:20992
v_mfma_f32_16x16x32_bf16 v[44:47], a[76:79], a[36:39], v[44:47]
ds_read_b64_tr_b16 a[52:53], v30 offset:24576
v_mfma_f32_16x16x32_bf16 v[44:47], a[80:83], a[40:43], v[44:47]
ds_read_b64_tr_b16 a[54:55], v30 offset:25088
v_mfma_f32_16x16x32_bf16 v[44:47], a[84:87], a[44:47], v[44:47]
ds_read_b64_tr_b16 a[56:57], v30 offset:28672
v_mfma_f32_16x16x32_bf16 v[60:63], a[84:87], a[0:3], v[60:63]
ds_read_b64_tr_b16 a[58:59], v30 offset:29184
v_mfma_f32_16x16x32_bf16 v[60:63], a[80:83], a[44:47], v[60:63]
ds_read_b64_tr_b16 a[60:61], v30 offset:32768
v_mfma_f32_16x16x32_bf16 v[60:63], a[76:79], a[40:43], v[60:63]
ds_read_b64_tr_b16 a[62:63], v30 offset:33280
v_mfma_f32_16x16x32_bf16 v[60:63], a[72:75], a[36:39], v[60:63]
ds_read_b64_tr_b16 a[64:65], v30 offset:36864
v_mfma_f32_16x16x32_bf16 v[60:63], a[68:71], a[32:35], v[60:63]
ds_read_b64_tr_b16 a[66:67], v30 offset:37376
v_mfma_f32_16x16x32_bf16 v[76:79], a[68:71], a[36:39], v[76:79]
v_mfma_f32_16x16x32_bf16 v[76:79], a[72:75], a[40:43], v[76:79]
v_mfma_f32_16x16x32_bf16 v[76:79], a[76:79], a[44:47], v[76:79]
v_mfma_f32_16x16x32_bf16 v[76:79], a[80:83], a[0:3], v[76:79]
v_mfma_f32_16x16x32_bf16 v[76:79], a[84:87], a[4:7], v[76:79]
s_waitcnt lgkmcnt(0)
v_mfma_f32_16x16x32_bf16 v[48:51], a[48:51], a[28:31], v[48:51]
ds_read_b64_tr_b16 a[68:69], v31 offset:20480
v_mfma_f32_16x16x32_bf16 v[48:51], a[52:55], a[32:35], v[48:51]
ds_read_b64_tr_b16 a[70:71], v31 offset:20992
v_mfma_f32_16x16x32_bf16 v[48:51], a[56:59], a[36:39], v[48:51]
ds_read_b64_tr_b16 a[72:73], v31 offset:24576
v_mfma_f32_16x16x32_bf16 v[48:51], a[60:63], a[40:43], v[48:51]
ds_read_b64_tr_b16 a[74:75], v31 offset:25088
v_mfma_f32_16x16x32_bf16 v[48:51], a[64:67], a[44:47], v[48:51]
ds_read_b64_tr_b16 a[76:77], v31 offset:28672
v_mfma_f32_16x16x32_bf16 v[64:67], a[64:67], a[0:3], v[64:67]
ds_read_b64_tr_b16 a[78:79], v31 offset:29184
v_mfma_f32_16x16x32_bf16 v[64:67], a[60:63], a[44:47], v[64:67]
ds_read_b64_tr_b16 a[80:81], v31 offset:32768
v_mfma_f32_16x16x32_bf16 v[64:67], a[56:59], a[40:43], v[64:67]
ds_read_b64_tr_b16 a[82:83], v31 offset:33280
v_mfma_f32_16x16x32_bf16 v[64:67], a[52:55], a[36:39], v[64:67]
ds_read_b64_tr_b16 a[84:85], v31 offset:36864
v_mfma_f32_16x16x32_bf16 v[64:67], a[48:51], a[32:35], v[64:67]
ds_read_b64_tr_b16 a[86:87], v31 offset:37376
v_mfma_f32_16x16x32_bf16 v[80:83], a[48:51], a[36:39], v[80:83]
v_mfma_f32_16x16x32_bf16 v[80:83], a[52:55], a[40:43], v[80:83]
v_mfma_f32_16x16x32_bf16 v[80:83], a[56:59], a[44:47], v[80:83]
v_mfma_f32_16x16x32_bf16 v[80:83], a[60:63], a[0:3], v[80:83]
v_mfma_f32_16x16x32_bf16 v[80:83], a[64:67], a[4:7], v[80:83]
s_waitcnt lgkmcnt(0)
v_mfma_f32_16x16x32_bf16 v[52:55], a[68:71], a[28:31], v[52:55]
ds_read_b64_tr_b16 a[48:49], v1 offset:0
ds_read_b128 a[28:31], v4 offset:0
v_mfma_f32_16x16x32_bf16 v[52:55], a[72:75], a[32:35], v[52:55]
ds_read_b64_tr_b16 a[50:51], v1 offset:512
v_mfma_f32_16x16x32_bf16 v[52:55], a[76:79], a[36:39], v[52:55]
ds_read_b64_tr_b16 a[52:53], v1 offset:4096
v_mfma_f32_16x16x32_bf16 v[52:55], a[80:83], a[40:43], v[52:55]
ds_read_b64_tr_b16 a[54:55], v1 offset:4608
v_mfma_f32_16x16x32_bf16 v[52:55], a[84:87], a[44:47], v[52:55]
ds_read_b64_tr_b16 a[56:57], v1 offset:8192
v_mfma_f32_16x16x32_bf16 v[68:71], a[84:87], a[0:3], v[68:71]
ds_read_b64_tr_b16 a[58:59], v1 offset:8704
v_mfma_f32_16x16x32_bf16 v[68:71], a[80:83], a[44:47], v[68:71]
ds_read_b64_tr_b16 a[60:61], v1 offset:12288
v_mfma_f32_16x16x32_bf16 v[68:71], a[76:79], a[40:43], v[68:71]
ds_read_b64_tr_b16 a[62:63], v1 offset:12800
v_mfma_f32_16x16x32_bf16 v[68:71], a[72:75], a[36:39], v[68:71]
ds_read_b64_tr_b16 a[64:65], v1 offset:16384
v_mfma_f32_16x16x32_bf16 v[68:71], a[68:71], a[32:35], v[68:71]
ds_read_b64_tr_b16 a[66:67], v1 offset:16896
ds_read_b128 a[32:35], v5 offset:0
v_mfma_f32_16x16x32_bf16 v[84:87], a[68:71], a[36:39], v[84:87]
ds_read_b128 a[36:39], v6 offset:0
v_mfma_f32_16x16x32_bf16 v[84:87], a[72:75], a[40:43], v[84:87]
ds_read_b128 a[40:43], v7 offset:0
v_mfma_f32_16x16x32_bf16 v[84:87], a[76:79], a[44:47], v[84:87]
v_mfma_f32_16x16x32_bf16 v[84:87], a[80:83], a[0:3], v[84:87]
v_mfma_f32_16x16x32_bf16 v[84:87], a[84:87], a[4:7], v[84:87]
s_waitcnt lgkmcnt(2)
v_mfma_f32_16x16x32_bf16 v[88:91], a[48:51], a[8:11], v[88:91]
ds_read_b64_tr_b16 a[68:69], v2 offset:0
v_mfma_f32_16x16x32_bf16 v[88:91], a[52:55], a[12:15], v[88:91]
v_mfma_f32_16x16x32_bf16 v[88:91], a[56:59], a[16:19], v[88:91]
ds_read_b64_tr_b16 a[70:71], v2 offset:512
v_mul_f32 v10, s36, v40
v_mfma_f32_16x16x32_bf16 v[88:91], a[60:63], a[20:23], v[88:91]
v_mul_f32 v11, s36, v41
v_mul_f32 v12, s36, v42
v_mfma_f32_16x16x32_bf16 v[88:91], a[64:67], a[24:27], v[88:91]
ds_read_b64_tr_b16 a[72:73], v2 offset:4096
v_mul_f32 v13, s36, v43
v_mfma_f32_16x16x32_bf16 v[104:107], a[64:67], a[28:31], v[104:107]
v_mul_f32 v14, s36, v44
v_mul_f32 v15, s36, v45
v_mfma_f32_16x16x32_bf16 v[104:107], a[60:63], a[24:27], v[104:107]
ds_read_b64_tr_b16 a[74:75], v2 offset:4608
v_mul_f32 v16, s36, v46
v_mfma_f32_16x16x32_bf16 v[104:107], a[56:59], a[20:23], v[104:107]
v_mul_f32 v17, s36, v47
v_mul_f32 v48, s38, v48
v_mfma_f32_16x16x32_bf16 v[104:107], a[52:55], a[16:19], v[104:107]
ds_read_b64_tr_b16 a[76:77], v2 offset:8192
v_mul_f32 v49, s38, v49
v_mfma_f32_16x16x32_bf16 v[104:107], a[48:51], a[12:15], v[104:107]
v_mul_f32 v50, s38, v50
v_mul_f32 v51, s38, v51
v_mfma_f32_16x16x32_bf16 v[120:123], a[48:51], a[16:19], v[120:123]
ds_read_b64_tr_b16 a[78:79], v2 offset:8704
v_mul_f32 v52, s38, v52
v_mfma_f32_16x16x32_bf16 v[120:123], a[52:55], a[20:23], v[120:123]
v_mul_f32 v53, s38, v53
v_mul_f32 v54, s38, v54
v_mfma_f32_16x16x32_bf16 v[120:123], a[56:59], a[24:27], v[120:123]
ds_read_b64_tr_b16 a[80:81], v2 offset:12288
v_mul_f32 v55, s38, v55
v_mfma_f32_16x16x32_bf16 v[120:123], a[60:63], a[28:31], v[120:123]
v_exp_f32 v10, -|v10|
v_mfma_f32_16x16x32_bf16 v[120:123], a[64:67], a[32:35], v[120:123]
ds_read_b64_tr_b16 a[82:83], v2 offset:12800
s_waitcnt lgkmcnt(3)
v_mfma_f32_16x16x32_bf16 v[136:139], a[64:67], a[36:39], v[136:139]
v_exp_f32 v11, -|v11|
v_mfma_f32_16x16x32_bf16 v[136:139], a[60:63], a[32:35], v[136:139]
ds_read_b64_tr_b16 a[84:85], v2 offset:16384
v_exp_f32 v12, -|v12|
v_mfma_f32_16x16x32_bf16 v[136:139], a[56:59], a[28:31], v[136:139]
v_exp_f32 v13, -|v13|
v_mfma_f32_16x16x32_bf16 v[136:139], a[52:55], a[24:27], v[136:139]
ds_read_b64_tr_b16 a[86:87], v2 offset:16896
v_mfma_f32_16x16x32_bf16 v[136:139], a[48:51], a[20:23], v[136:139]
v_exp_f32 v14, -|v14|
v_mfma_f32_16x16x32_bf16 v[152:155], a[48:51], a[24:27], v[152:155]
v_exp_f32 v15, -|v15|
v_mfma_f32_16x16x32_bf16 v[152:155], a[52:55], a[28:31], v[152:155]
v_exp_f32 v16, -|v16|
v_mfma_f32_16x16x32_bf16 v[152:155], a[56:59], a[32:35], v[152:155]
v_exp_f32 v17, -|v17|
v_mfma_f32_16x16x32_bf16 v[152:155], a[60:63], a[36:39], v[152:155]
v_exp_f32 v48, v48
v_mfma_f32_16x16x32_bf16 v[152:155], a[64:67], a[40:43], v[152:155]
v_exp_f32 v49, v49
v_mfma_f32_16x16x32_bf16 v[92:95], a[68:71], a[8:11], v[92:95]
ds_read_b64_tr_b16 a[48:49], v1 offset:20480
v_exp_f32 v50, v50
v_mfma_f32_16x16x32_bf16 v[92:95], a[72:75], a[12:15], v[92:95]
v_exp_f32 v51, v51
s_waitcnt lgkmcnt(1)
v_mfma_f32_16x16x32_bf16 v[92:95], a[76:79], a[16:19], v[92:95]
ds_read_b64_tr_b16 a[50:51], v1 offset:20992
v_mfma_f32_16x16x32_bf16 v[92:95], a[80:83], a[20:23], v[92:95]
v_exp_f32 v52, v52
v_mfma_f32_16x16x32_bf16 v[92:95], a[84:87], a[24:27], v[92:95]
ds_read_b64_tr_b16 a[52:53], v1 offset:24576
v_exp_f32 v53, v53
v_mfma_f32_16x16x32_bf16 v[108:111], a[84:87], a[28:31], v[108:111]
v_exp_f32 v54, v54
v_mfma_f32_16x16x32_bf16 v[108:111], a[80:83], a[24:27], v[108:111]
ds_read_b64_tr_b16 a[54:55], v1 offset:25088
v_mfma_f32_16x16x32_bf16 v[108:111], a[76:79], a[20:23], v[108:111]
v_exp_f32 v55, v55
v_bfi_b32 v40, s42, 1.0, v40
v_mfma_f32_16x16x32_bf16 v[108:111], a[72:75], a[16:19], v[108:111]
ds_read_b64_tr_b16 a[56:57], v1 offset:28672
v_bfi_b32 v41, s42, 1.0, v41
v_mfma_f32_16x16x32_bf16 v[108:111], a[68:71], a[12:15], v[108:111]
v_bfi_b32 v42, s42, 1.0, v42
v_bfi_b32 v43, s42, 1.0, v43
v_mfma_f32_16x16x32_bf16 v[124:127], a[68:71], a[16:19], v[124:127]
ds_read_b64_tr_b16 a[58:59], v1 offset:29184
v_bfi_b32 v44, s42, 1.0, v44
v_mfma_f32_16x16x32_bf16 v[124:127], a[72:75], a[20:23], v[124:127]
v_bfi_b32 v45, s42, 1.0, v45
v_bfi_b32 v46, s42, 1.0, v46
v_mfma_f32_16x16x32_bf16 v[124:127], a[76:79], a[24:27], v[124:127]
ds_read_b64_tr_b16 a[60:61], v1 offset:32768
v_bfi_b32 v47, s42, 1.0, v47
v_mfma_f32_16x16x32_bf16 v[124:127], a[80:83], a[28:31], v[124:127]
v_fmac_f32 v40, v10, v40
v_fmac_f32 v41, v11, v41
v_mfma_f32_16x16x32_bf16 v[124:127], a[84:87], a[32:35], v[124:127]
ds_read_b64_tr_b16 a[62:63], v1 offset:33280
v_fmac_f32 v42, v12, v42
v_mfma_f32_16x16x32_bf16 v[140:143], a[84:87], a[36:39], v[140:143]
ds_read_b128 a[44:47], v3 offset:12800
v_fmac_f32 v43, v13, v43
v_mfma_f32_16x16x32_bf16 v[140:143], a[80:83], a[32:35], v[140:143]
ds_read_b64_tr_b16 a[64:65], v1 offset:36864
ds_read_b128 a[0:3], v3 offset:16896
v_mfma_f32_16x16x32_bf16 v[140:143], a[76:79], a[28:31], v[140:143]
ds_read_b128 a[4:7], v3 offset:20992
v_fmac_f32 v44, v14, v44
v_mfma_f32_16x16x32_bf16 v[140:143], a[72:75], a[24:27], v[140:143]
ds_read_b64_tr_b16 a[66:67], v1 offset:37376
v_fmac_f32 v45, v15, v45
v_mfma_f32_16x16x32_bf16 v[140:143], a[68:71], a[20:23], v[140:143]
v_fmac_f32 v46, v16, v46
v_fmac_f32 v47, v17, v47
v_mfma_f32_16x16x32_bf16 v[156:159], a[68:71], a[24:27], v[156:159]
v_fmac_f32 v40, v48, v40
v_fmac_f32 v41, v49, v41
v_mfma_f32_16x16x32_bf16 v[156:159], a[72:75], a[28:31], v[156:159]
v_fmac_f32 v42, v50, v42
v_fmac_f32 v43, v51, v43
v_mfma_f32_16x16x32_bf16 v[156:159], a[76:79], a[32:35], v[156:159]
v_fmac_f32 v44, v52, v44
v_fmac_f32 v45, v53, v45
v_mfma_f32_16x16x32_bf16 v[156:159], a[80:83], a[36:39], v[156:159]
v_fmac_f32 v46, v54, v46
v_fmac_f32 v47, v55, v47
v_mfma_f32_16x16x32_bf16 v[156:159], a[84:87], a[40:43], v[156:159]
v_rcp_f32 v40, v40
s_waitcnt lgkmcnt(0)
v_mfma_f32_16x16x32_bf16 v[96:99], a[48:51], a[8:11], v[96:99]
ds_read_b64_tr_b16 a[68:69], v2 offset:20480
v_mfma_f32_16x16x32_bf16 v[96:99], a[52:55], a[12:15], v[96:99]
v_rcp_f32 v41, v41
v_mfma_f32_16x16x32_bf16 v[96:99], a[56:59], a[16:19], v[96:99]
ds_read_b64_tr_b16 a[70:71], v2 offset:20992
v_rcp_f32 v42, v42
v_mfma_f32_16x16x32_bf16 v[96:99], a[60:63], a[20:23], v[96:99]
v_rcp_f32 v43, v43
v_mfma_f32_16x16x32_bf16 v[96:99], a[64:67], a[24:27], v[96:99]
ds_read_b64_tr_b16 a[72:73], v2 offset:24576
v_mfma_f32_16x16x32_bf16 v[112:115], a[64:67], a[28:31], v[112:115]
v_rcp_f32 v44, v44
v_mfma_f32_16x16x32_bf16 v[112:115], a[60:63], a[24:27], v[112:115]
ds_read_b64_tr_b16 a[74:75], v2 offset:25088
v_rcp_f32 v45, v45
v_mfma_f32_16x16x32_bf16 v[112:115], a[56:59], a[20:23], v[112:115]
v_rcp_f32 v46, v46
v_mfma_f32_16x16x32_bf16 v[112:115], a[52:55], a[16:19], v[112:115]
ds_read_b64_tr_b16 a[76:77], v2 offset:28672
v_mfma_f32_16x16x32_bf16 v[112:115], a[48:51], a[12:15], v[112:115]
v_rcp_f32 v47, v47
v_fma_f32 v10, -v10, v40, v40
v_mfma_f32_16x16x32_bf16 v[128:131], a[48:51], a[16:19], v[128:131]
ds_read_b64_tr_b16 a[78:79], v2 offset:29184
v_fma_f32 v11, -v11, v41, v41
v_mfma_f32_16x16x32_bf16 v[128:131], a[52:55], a[20:23], v[128:131]
v_fma_f32 v12, -v12, v42, v42
v_fma_f32 v13, -v13, v43, v43
v_mfma_f32_16x16x32_bf16 v[128:131], a[56:59], a[24:27], v[128:131]
ds_read_b64_tr_b16 a[80:81], v2 offset:32768
v_fma_f32 v14, -v14, v44, v44
v_mfma_f32_16x16x32_bf16 v[128:131], a[60:63], a[28:31], v[128:131]
v_fma_f32 v15, -v15, v45, v45
v_fma_f32 v16, -v16, v46, v46
v_mfma_f32_16x16x32_bf16 v[128:131], a[64:67], a[32:35], v[128:131]
ds_read_b64_tr_b16 a[82:83], v2 offset:33280
v_fma_f32 v17, -v17, v47, v47
v_mfma_f32_16x16x32_bf16 v[144:147], a[64:67], a[36:39], v[144:147]
v_cvt_pk_bf16_f32 v20, v10, v11
v_cvt_pk_bf16_f32 v21, v12, v13
v_mfma_f32_16x16x32_bf16 v[144:147], a[60:63], a[32:35], v[144:147]
ds_read_b64_tr_b16 a[84:85], v2 offset:36864
v_cvt_pk_bf16_f32 v22, v14, v15
v_mfma_f32_16x16x32_bf16 v[144:147], a[56:59], a[28:31], v[144:147]
v_cvt_pk_bf16_f32 v23, v16, v17
v_mul_f32 v10, s36, v56
v_mfma_f32_16x16x32_bf16 v[144:147], a[52:55], a[24:27], v[144:147]
ds_read_b64_tr_b16 a[86:87], v2 offset:37376
v_mul_f32 v11, s36, v57
v_mfma_f32_16x16x32_bf16 v[144:147], a[48:51], a[20:23], v[144:147]
ds_write_b64 v28, v[20:21] offset:0
ds_write_b64 v29, v[22:23] offset:0
v_mfma_f32_16x16x32_bf16 v[160:163], a[48:51], a[24:27], v[160:163]
ds_read_b128 v[32:35], v18 offset:0
v_mul_f32 v12, s36, v58
v_mfma_f32_16x16x32_bf16 v[160:163], a[52:55], a[28:31], v[160:163]
v_mul_f32 v13, s36, v59
v_mul_f32 v14, s36, v60
v_mfma_f32_16x16x32_bf16 v[160:163], a[56:59], a[32:35], v[160:163]
v_mul_f32 v15, s36, v61
v_mul_f32 v16, s36, v62
v_mfma_f32_16x16x32_bf16 v[160:163], a[60:63], a[36:39], v[160:163]
v_mul_f32 v17, s36, v63
v_mul_f32 v64, s38, v64
v_mfma_f32_16x16x32_bf16 v[160:163], a[64:67], a[40:43], v[160:163]
v_mul_f32 v65, s38, v65
v_mul_f32 v66, s38, v66
s_waitcnt lgkmcnt(1)
v_mfma_f32_16x16x32_bf16 v[100:103], a[68:71], a[8:11], v[100:103]
ds_read_b64_tr_b16 a[48:49], v30 offset:0
ds_read_b128 a[8:11], v3 offset:25088
v_mfma_f32_16x16x32_bf16 v[100:103], a[72:75], a[12:15], v[100:103]
v_mul_f32 v67, s38, v67
v_mul_f32 v68, s38, v68
v_mfma_f32_16x16x32_bf16 v[100:103], a[76:79], a[16:19], v[100:103]
ds_read_b64_tr_b16 a[50:51], v30 offset:512
v_mul_f32 v69, s38, v69
v_mfma_f32_16x16x32_bf16 v[100:103], a[80:83], a[20:23], v[100:103]
v_mul_f32 v70, s38, v70
v_mul_f32 v71, s38, v71
v_mfma_f32_16x16x32_bf16 v[100:103], a[84:87], a[24:27], v[100:103]
ds_read_b64_tr_b16 a[52:53], v30 offset:4096
v_mfma_f32_16x16x32_bf16 v[116:119], a[84:87], a[28:31], v[116:119]
v_exp_f32 v10, -|v10|
v_mfma_f32_16x16x32_bf16 v[116:119], a[80:83], a[24:27], v[116:119]
ds_read_b64_tr_b16 a[54:55], v30 offset:4608
v_exp_f32 v11, -|v11|
v_mfma_f32_16x16x32_bf16 v[116:119], a[76:79], a[20:23], v[116:119]
v_exp_f32 v12, -|v12|
v_mfma_f32_16x16x32_bf16 v[116:119], a[72:75], a[16:19], v[116:119]
ds_read_b64_tr_b16 a[56:57], v30 offset:8192
v_mfma_f32_16x16x32_bf16 v[116:119], a[68:71], a[12:15], v[116:119]
ds_read_b128 a[12:15], v3 offset:29184
v_exp_f32 v13, -|v13|
v_mfma_f32_16x16x32_bf16 v[132:135], a[68:71], a[16:19], v[132:135]
ds_read_b64_tr_b16 a[58:59], v30 offset:8704
ds_read_b128 a[16:19], v4 offset:512
v_mfma_f32_16x16x32_bf16 v[132:135], a[72:75], a[20:23], v[132:135]
s_waitcnt lgkmcnt(4)
buffer_store_dwordx4 v[32:35], v8, s[20:23], 0 offen offset:0 nt
v_mfma_f32_16x16x32_bf16 v[132:135], a[76:79], a[24:27], v[132:135]
ds_read_b64_tr_b16 a[60:61], v30 offset:12288
v_exp_f32 v14, -|v14|
v_mfma_f32_16x16x32_bf16 v[132:135], a[80:83], a[28:31], v[132:135]
v_exp_f32 v15, -|v15|
v_mfma_f32_16x16x32_bf16 v[132:135], a[84:87], a[32:35], v[132:135]
ds_read_b64_tr_b16 a[62:63], v30 offset:12800
v_mfma_f32_16x16x32_bf16 v[148:151], a[84:87], a[36:39], v[148:151]
v_exp_f32 v16, -|v16|
v_mfma_f32_16x16x32_bf16 v[148:151], a[80:83], a[32:35], v[148:151]
ds_read_b64_tr_b16 a[64:65], v30 offset:16384
v_exp_f32 v17, -|v17|
v_mfma_f32_16x16x32_bf16 v[148:151], a[76:79], a[28:31], v[148:151]
v_exp_f32 v64, v64
v_mfma_f32_16x16x32_bf16 v[148:151], a[72:75], a[24:27], v[148:151]
ds_read_b64_tr_b16 a[66:67], v30 offset:16896
v_mfma_f32_16x16x32_bf16 v[148:151], a[68:71], a[20:23], v[148:151]
ds_read_b128 a[20:23], v5 offset:512
v_exp_f32 v65, v65
v_mfma_f32_16x16x32_bf16 v[164:167], a[68:71], a[24:27], v[164:167]
ds_read_b128 a[24:27], v6 offset:512
v_mfma_f32_16x16x32_bf16 v[164:167], a[72:75], a[28:31], v[164:167]
ds_read_b128 a[28:31], v7 offset:512
v_exp_f32 v66, v66
v_mfma_f32_16x16x32_bf16 v[164:167], a[76:79], a[32:35], v[164:167]
v_exp_f32 v67, v67
v_mfma_f32_16x16x32_bf16 v[164:167], a[80:83], a[36:39], v[164:167]
v_exp_f32 v68, v68
v_mfma_f32_16x16x32_bf16 v[164:167], a[84:87], a[40:43], v[164:167]
v_exp_f32 v69, v69
v_mfma_f32_16x16x32_bf16 v[88:91], a[48:51], a[44:47], v[88:91]
ds_read_b64_tr_b16 a[68:69], v31 offset:0
v_mfma_f32_16x16x32_bf16 v[88:91], a[52:55], a[0:3], v[88:91]
v_exp_f32 v70, v70
s_waitcnt lgkmcnt(1)
v_mfma_f32_16x16x32_bf16 v[88:91], a[56:59], a[4:7], v[88:91]
ds_read_b64_tr_b16 a[70:71], v31 offset:512
v_exp_f32 v71, v71
v_mfma_f32_16x16x32_bf16 v[88:91], a[60:63], a[8:11], v[88:91]
v_bfi_b32 v56, s42, 1.0, v56
v_bfi_b32 v57, s42, 1.0, v57
v_mfma_f32_16x16x32_bf16 v[88:91], a[64:67], a[12:15], v[88:91]
ds_read_b64_tr_b16 a[72:73], v31 offset:4096
v_bfi_b32 v58, s42, 1.0, v58
v_mfma_f32_16x16x32_bf16 v[104:107], a[64:67], a[16:19], v[104:107]
v_bfi_b32 v59, s42, 1.0, v59
v_bfi_b32 v60, s42, 1.0, v60
v_mfma_f32_16x16x32_bf16 v[104:107], a[60:63], a[12:15], v[104:107]
ds_read_b64_tr_b16 a[74:75], v31 offset:4608
v_bfi_b32 v61, s42, 1.0, v61
v_mfma_f32_16x16x32_bf16 v[104:107], a[56:59], a[8:11], v[104:107]
v_bfi_b32 v62, s42, 1.0, v62
v_bfi_b32 v63, s42, 1.0, v63
v_mfma_f32_16x16x32_bf16 v[104:107], a[52:55], a[4:7], v[104:107]
ds_read_b64_tr_b16 a[76:77], v31 offset:8192
v_fmac_f32 v56, v10, v56
v_mfma_f32_16x16x32_bf16 v[104:107], a[48:51], a[0:3], v[104:107]
v_fmac_f32 v57, v11, v57
v_fmac_f32 v58, v12, v58
v_mfma_f32_16x16x32_bf16 v[120:123], a[48:51], a[4:7], v[120:123]
ds_read_b64_tr_b16 a[78:79], v31 offset:8704
v_fmac_f32 v59, v13, v59
v_mfma_f32_16x16x32_bf16 v[120:123], a[52:55], a[8:11], v[120:123]
v_fmac_f32 v60, v14, v60
v_fmac_f32 v61, v15, v61
v_mfma_f32_16x16x32_bf16 v[120:123], a[56:59], a[12:15], v[120:123]
ds_read_b64_tr_b16 a[80:81], v31 offset:12288
v_fmac_f32 v62, v16, v62
v_mfma_f32_16x16x32_bf16 v[120:123], a[60:63], a[16:19], v[120:123]
v_fmac_f32 v63, v17, v63
v_fmac_f32 v56, v64, v56
v_mfma_f32_16x16x32_bf16 v[120:123], a[64:67], a[20:23], v[120:123]
ds_read_b64_tr_b16 a[82:83], v31 offset:12800
L_pad1:
s_cbranch_scc1 L_back1
s_nop 0
v_fmac_f32 v57, v65, v57
v_mfma_f32_16x16x32_bf16 v[136:139], a[64:67], a[24:27], v[136:139]
v_fmac_f32 v58, v66, v58
v_fmac_f32 v59, v67, v59
v_mfma_f32_16x16x32_bf16 v[136:139], a[60:63], a[20:23], v[136:139]
ds_read_b64_tr_b16 a[84:85], v31 offset:16384
v_fmac_f32 v60, v68, v60
v_mfma_f32_16x16x32_bf16 v[136:139], a[56:59], a[16:19], v[136:139]
v_fmac_f32 v61, v69, v61
v_fmac_f32 v62, v70, v62
v_mfma_f32_16x16x32_bf16 v[136:139], a[52:55], a[12:15], v[136:139]
ds_read_b64_tr_b16 a[86:87], v31 offset:16896
v_fmac_f32 v63, v71, v63
v_mfma_f32_16x16x32_bf16 v[136:139], a[48:51], a[8:11], v[136:139]
v_rcp_f32 v56, v56
v_mfma_f32_16x16x32_bf16 v[152:155], a[48:51], a[12:15], v[152:155]
v_rcp_f32 v57, v57
v_mfma_f32_16x16x32_bf16 v[152:155], a[52:55], a[16:19], v[152:155]
v_rcp_f32 v58, v58
v_mfma_f32_16x16x32_bf16 v[152:155], a[56:59], a[20:23], v[152:155]
v_rcp_f32 v59, v59
v_mfma_f32_16x16x32_bf16 v[152:155], a[60:63], a[24:27], v[152:155]
v_rcp_f32 v60, v60
v_mfma_f32_16x16x32_bf16 v[152:155], a[64:67], a[28:31], v[152:155]
v_rcp_f32 v61, v61
s_waitcnt lgkmcnt(0)
v_mfma_f32_16x16x32_bf16 v[92:95], a[68:71], a[44:47], v[92:95]
ds_read_b64_tr_b16 a[48:49], v30 offset:20480
v_mfma_f32_16x16x32_bf16 v[92:95], a[72:75], a[0:3], v[92:95]
v_rcp_f32 v62, v62
v_mfma_f32_16x16x32_bf16 v[92:95], a[76:79], a[4:7], v[92:95]
ds_read_b64_tr_b16 a[50:51], v30 offset:20992
v_rcp_f32 v63, v63
v_mfma_f32_16x16x32_bf16 v[92:95], a[80:83], a[8:11], v[92:95]
v_fma_f32 v10, -v10, v56, v56
v_fma_f32 v11, -v11, v57, v57
v_mfma_f32_16x16x32_bf16 v[92:95], a[84:87], a[12:15], v[92:95]
ds_read_b64_tr_b16 a[52:53], v30 offset:24576
v_fma_f32 v12, -v12, v58, v58
v_mfma_f32_16x16x32_bf16 v[108:111], a[84:87], a[16:19], v[108:111]
v_fma_f32 v13, -v13, v59, v59
v_fma_f32 v14, -v14, v60, v60
v_mfma_f32_16x16x32_bf16 v[108:111], a[80:83], a[12:15], v[108:111]
ds_read_b64_tr_b16 a[54:55], v30 offset:25088
v_fma_f32 v15, -v15, v61, v61
v_mfma_f32_16x16x32_bf16 v[108:111], a[76:79], a[8:11], v[108:111]
v_fma_f32 v16, -v16, v62, v62
v_fma_f32 v17, -v17, v63, v63
v_mfma_f32_16x16x32_bf16 v[108:111], a[72:75], a[4:7], v[108:111]
ds_read_b64_tr_b16 a[56:57], v30 offset:28672
v_cvt_pk_bf16_f32 v24, v10, v11
v_mfma_f32_16x16x32_bf16 v[108:111], a[68:71], a[0:3], v[108:111]
v_cvt_pk_bf16_f32 v25, v12, v13
v_cvt_pk_bf16_f32 v26, v14, v15
v_mfma_f32_16x16x32_bf16 v[124:127], a[68:71], a[4:7], v[124:127]
ds_read_b64_tr_b16 a[58:59], v30 offset:29184
v_cvt_pk_bf16_f32 v27, v16, v17
v_mfma_f32_16x16x32_bf16 v[124:127], a[72:75], a[8:11], v[124:127]
v_mul_f32 v10, s36, v72
v_mul_f32 v11, s36, v73
v_mfma_f32_16x16x32_bf16 v[124:127], a[76:79], a[12:15], v[124:127]
ds_read_b64_tr_b16 a[60:61], v30 offset:32768
ds_write_b64 v28, v[24:25] offset:1024
v_mfma_f32_16x16x32_bf16 v[124:127], a[80:83], a[16:19], v[124:127]
ds_write_b64 v29, v[26:27] offset:1024
ds_read_b128 v[36:39], v18 offset:1024
v_mfma_f32_16x16x32_bf16 v[124:127], a[84:87], a[20:23], v[124:127]
ds_read_b64_tr_b16 a[62:63], v30 offset:33280
v_mul_f32 v12, s36, v74
v_mfma_f32_16x16x32_bf16 v[140:143], a[84:87], a[24:27], v[140:143]
v_mul_f32 v13, s36, v75
v_mul_f32 v14, s36, v76
v_mfma_f32_16x16x32_bf16 v[140:143], a[80:83], a[20:23], v[140:143]
ds_read_b64_tr_b16 a[64:65], v30 offset:36864
v_mul_f32 v15, s36, v77
v_mfma_f32_16x16x32_bf16 v[140:143], a[76:79], a[16:19], v[140:143]
v_mul_f32 v16, s36, v78
v_mul_f32 v17, s36, v79
v_mfma_f32_16x16x32_bf16 v[140:143], a[72:75], a[12:15], v[140:143]
ds_read_b64_tr_b16 a[66:67], v30 offset:37376
v_mul_f32 v80, s38, v80
v_mfma_f32_16x16x32_bf16 v[140:143], a[68:71], a[8:11], v[140:143]
v_mul_f32 v81, s38, v81
v_mul_f32 v82, s38, v82
v_mfma_f32_16x16x32_bf16 v[156:159], a[68:71], a[12:15], v[156:159]
v_mul_f32 v83, s38, v83
v_mul_f32 v84, s38, v84
v_mfma_f32_16x16x32_bf16 v[156:159], a[72:75], a[16:19], v[156:159]
v_mul_f32 v85, s38, v85
v_mul_f32 v86, s38, v86
v_mfma_f32_16x16x32_bf16 v[156:159], a[76:79], a[20:23], v[156:159]
v_mul_f32 v87, s38, v87
v_mfma_f32_16x16x32_bf16 v[156:159], a[80:83], a[24:27], v[156:159]
v_exp_f32 v10, -|v10|
v_mfma_f32_16x16x32_bf16 v[156:159], a[84:87], a[28:31], v[156:159]
v_exp_f32 v11, -|v11|
s_waitcnt lgkmcnt(0)
v_mfma_f32_16x16x32_bf16 v[96:99], a[48:51], a[44:47], v[96:99]
ds_read_b64_tr_b16 a[68:69], v31 offset:20480
v_exp_f32 v12, -|v12|
v_mfma_f32_16x16x32_bf16 v[96:99], a[52:55], a[0:3], v[96:99]
v_exp_f32 v13, -|v13|
v_mfma_f32_16x16x32_bf16 v[96:99], a[56:59], a[4:7], v[96:99]
ds_read_b64_tr_b16 a[70:71], v31 offset:20992
buffer_store_dwordx4 v[36:39], v8, s[20:23], 0 offen offset:2048 nt
v_mfma_f32_16x16x32_bf16 v[96:99], a[60:63], a[8:11], v[96:99]
v_exp_f32 v14, -|v14|
v_mfma_f32_16x16x32_bf16 v[96:99], a[64:67], a[12:15], v[96:99]
ds_read_b64_tr_b16 a[72:73], v31 offset:24576
v_mfma_f32_16x16x32_bf16 v[112:115], a[64:67], a[16:19], v[112:115]
v_exp_f32 v15, -|v15|
v_mfma_f32_16x16x32_bf16 v[112:115], a[60:63], a[12:15], v[112:115]
ds_read_b64_tr_b16 a[74:75], v31 offset:25088
v_exp_f32 v16, -|v16|
v_mfma_f32_16x16x32_bf16 v[112:115], a[56:59], a[8:11], v[112:115]
v_exp_f32 v17, -|v17|
v_mfma_f32_16x16x32_bf16 v[112:115], a[52:55], a[4:7], v[112:115]
ds_read_b64_tr_b16 a[76:77], v31 offset:28672
v_mfma_f32_16x16x32_bf16 v[112:115], a[48:51], a[0:3], v[112:115]
v_exp_f32 v80, v80
v_mfma_f32_16x16x32_bf16 v[128:131], a[48:51], a[4:7], v[128:131]
ds_read_b64_tr_b16 a[78:79], v31 offset:29184
v_exp_f32 v81, v81
v_mfma_f32_16x16x32_bf16 v[128:131], a[52:55], a[8:11], v[128:131]
v_exp_f32 v82, v82
v_mfma_f32_16x16x32_bf16 v[128:131], a[56:59], a[12:15], v[128:131]
ds_read_b64_tr_b16 a[80:81], v31 offset:32768
v_mfma_f32_16x16x32_bf16 v[128:131], a[60:63], a[16:19], v[128:131]
v_exp_f32 v83, v83
v_mfma_f32_16x16x32_bf16 v[128:131], a[64:67], a[20:23], v[128:131]
ds_read_b64_tr_b16 a[82:83], v31 offset:33280
v_exp_f32 v84, v84
v_mfma_f32_16x16x32_bf16 v[144:147], a[64:67], a[24:27], v[144:147]
v_exp_f32 v85, v85
v_mfma_f32_16x16x32_bf16 v[144:147], a[60:63], a[20:23], v[144:147]
ds_read_b64_tr_b16 a[84:85], v31 offset:36864
v_mfma_f32_16x16x32_bf16 v[144:147], a[56:59], a[16:19], v[144:147]
v_exp_f32 v86, v86
v_mfma_f32_16x16x32_bf16 v[144:147], a[52:55], a[12:15], v[144:147]
ds_read_b64_tr_b16 a[86:87], v31 offset:37376
v_exp_f32 v87, v87
v_mfma_f32_16x16x32_bf16 v[144:147], a[48:51], a[8:11], v[144:147]
v_bfi_b32 v72, s42, 1.0, v72
v_bfi_b32 v73, s42, 1.0, v73
v_mfma_f32_16x16x32_bf16 v[160:163], a[48:51], a[12:15], v[160:163]
v_bfi_b32 v74, s42, 1.0, v74
v_bfi_b32 v75, s42, 1.0, v75
v_mfma_f32_16x16x32_bf16 v[160:163], a[52:55], a[16:19], v[160:163]
v_bfi_b32 v76, s42, 1.0, v76
v_bfi_b32 v77, s42, 1.0, v77
v_mfma_f32_16x16x32_bf16 v[160:163], a[56:59], a[20:23], v[160:163]
v_bfi_b32 v78, s42, 1.0, v78
v_bfi_b32 v79, s42, 1.0, v79
v_mfma_f32_16x16x32_bf16 v[160:163], a[60:63], a[24:27], v[160:163]
v_fmac_f32 v72, v10, v72
v_fmac_f32 v73, v11, v73
v_mfma_f32_16x16x32_bf16 v[160:163], a[64:67], a[28:31], v[160:163]
v_fmac_f32 v74, v12, v74
v_fmac_f32 v75, v13, v75
s_waitcnt lgkmcnt(0)
v_mfma_f32_16x16x32_bf16 v[100:103], a[68:71], a[44:47], v[100:103]
v_fmac_f32 v76, v14, v76
v_fmac_f32 v77, v15, v77
v_mfma_f32_16x16x32_bf16 v[100:103], a[72:75], a[0:3], v[100:103]
v_fmac_f32 v78, v16, v78
v_fmac_f32 v79, v17, v79
v_mfma_f32_16x16x32_bf16 v[100:103], a[76:79], a[4:7], v[100:103]
v_fmac_f32 v72, v80, v72
v_fmac_f32 v73, v81, v73
v_mfma_f32_16x16x32_bf16 v[100:103], a[80:83], a[8:11], v[100:103]
v_fmac_f32 v74, v82, v74
v_fmac_f32 v75, v83, v75
v_mfma_f32_16x16x32_bf16 v[100:103], a[84:87], a[12:15], v[100:103]
v_fmac_f32 v76, v84, v76
v_fmac_f32 v77, v85, v77
v_mfma_f32_16x16x32_bf16 v[116:119], a[84:87], a[16:19], v[116:119]
v_fmac_f32 v78, v86, v78
v_fmac_f32 v79, v87, v79
v_mfma_f32_16x16x32_bf16 v[116:119], a[80:83], a[12:15], v[116:119]
v_rcp_f32 v72, v72
v_mfma_f32_16x16x32_bf16 v[116:119], a[76:79], a[8:11], v[116:119]
v_rcp_f32 v73, v73
v_mfma_f32_16x16x32_bf16 v[116:119], a[72:75], a[4:7], v[116:119]
v_rcp_f32 v74, v74
v_mfma_f32_16x16x32_bf16 v[116:119], a[68:71], a[0:3], v[116:119]
v_rcp_f32 v75, v75
v_mfma_f32_16x16x32_bf16 v[132:135], a[68:71], a[4:7], v[132:135]
v_rcp_f32 v76, v76
v_mfma_f32_16x16x32_bf16 v[132:135], a[72:75], a[8:11], v[132:135]
v_rcp_f32 v77, v77
v_mfma_f32_16x16x32_bf16 v[132:135], a[76:79], a[12:15], v[132:135]
v_rcp_f32 v78, v78
v_mfma_f32_16x16x32_bf16 v[132:135], a[80:83], a[16:19], v[132:135]
v_rcp_f32 v79, v79
v_mfma_f32_16x16x32_bf16 v[132:135], a[84:87], a[20:23], v[132:135]
v_fma_f32 v10, -v10, v72, v72
v_fma_f32 v11, -v11, v73, v73
v_mfma_f32_16x16x32_bf16 v[148:151], a[84:87], a[24:27], v[148:151]
v_fma_f32 v12, -v12, v74, v74
v_fma_f32 v13, -v13, v75, v75
v_mfma_f32_16x16x32_bf16 v[148:151], a[80:83], a[20:23], v[148:151]
v_fma_f32 v14, -v14, v76, v76
v_fma_f32 v15, -v15, v77, v77
v_mfma_f32_16x16x32_bf16 v[148:151], a[76:79], a[16:19], v[148:151]
v_fma_f32 v16, -v16, v78, v78
v_fma_f32 v17, -v17, v79, v79
v_mfma_f32_16x16x32_bf16 v[148:151], a[72:75], a[12:15], v[148:151]
v_cvt_pk_bf16_f32 v20, v10, v11
v_cvt_pk_bf16_f32 v21, v12, v13
v_mfma_f32_16x16x32_bf16 v[148:151], a[68:71], a[8:11], v[148:151]
v_cvt_pk_bf16_f32 v22, v14, v15
v_cvt_pk_bf16_f32 v23, v16, v17
v_mfma_f32_16x16x32_bf16 v[164:167], a[68:71], a[12:15], v[164:167]
ds_write_b64 v28, v[20:21] offset:2048
ds_write_b64 v29, v[22:23] offset:2048
v_mfma_f32_16x16x32_bf16 v[164:167], a[72:75], a[16:19], v[164:167]
ds_read_b128 v[32:35], v18 offset:2048
v_mfma_f32_16x16x32_bf16 v[164:167], a[76:79], a[20:23], v[164:167]
v_mfma_f32_16x16x32_bf16 v[164:167], a[80:83], a[24:27], v[164:167]
v_mfma_f32_16x16x32_bf16 v[164:167], a[84:87], a[28:31], v[164:167]
s_nop 7
v_pk_mul_f32 v[10:11], v[88:89], s[36:37]
v_pk_mul_f32 v[12:13], v[90:91], s[36:37]
v_pk_mul_f32 v[14:15], v[92:93], s[36:37]
v_pk_mul_f32 v[16:17], v[94:95], s[36:37]
v_pk_mul_f32 v[96:97], v[96:97], s[38:39]
v_pk_mul_f32 v[98:99], v[98:99], s[38:39]
v_pk_mul_f32 v[100:101], v[100:101], s[38:39]
v_pk_mul_f32 v[102:103], v[102:103], s[38:39]
v_exp_f32 v10, -|v10|
v_exp_f32 v11, -|v11|
v_exp_f32 v12, -|v12|
v_exp_f32 v13, -|v13|
v_exp_f32 v14, -|v14|
v_exp_f32 v15, -|v15|
v_exp_f32 v16, -|v16|
v_exp_f32 v17, -|v17|
s_mov_b32 s43, 4096
s_waitcnt lgkmcnt(0)
buffer_store_dwordx4 v[32:35], v8, s[20:23], s43 offen offset:0 nt
v_exp_f32 v96, v96
v_exp_f32 v97, v97
v_exp_f32 v98, v98
v_exp_f32 v99, v99
v_exp_f32 v100, v100
v_exp_f32 v101, v101
v_exp_f32 v102, v102
v_exp_f32 v103, v103
v_bfi_b32 v88, s42, 1.0, v88
v_bfi_b32 v89, s42, 1.0, v89
v_bfi_b32 v90, s42, 1.0, v90
v_bfi_b32 v91, s42, 1.0, v91
v_bfi_b32 v92, s42, 1.0, v92
v_bfi_b32 v93, s42, 1.0, v93
v_bfi_b32 v94, s42, 1.0, v94
v_bfi_b32 v95, s42, 1.0, v95
v_pk_fma_f32 v[88:89], v[10:11], v[88:89], v[88:89]
v_pk_fma_f32 v[90:91], v[12:13], v[90:91], v[90:91]
v_pk_fma_f32 v[92:93], v[14:15], v[92:93], v[92:93]
v_pk_fma_f32 v[94:95], v[16:17], v[94:95], v[94:95]
v_pk_fma_f32 v[88:89], v[96:97], v[88:89], v[88:89]
v_pk_fma_f32 v[90:91], v[98:99], v[90:91], v[90:91]
v_pk_fma_f32 v[92:93], v[100:101], v[92:93], v[92:93]
v_pk_fma_f32 v[94:95], v[102:103], v[94:95], v[94:95]
v_rcp_f32 v88, v88
v_rcp_f32 v89, v89
v_rcp_f32 v90, v90
v_rcp_f32 v91, v91
v_rcp_f32 v92, v92
v_rcp_f32 v93, v93
v_rcp_f32 v94, v94
v_rcp_f32 v95, v95
v_pk_fma_f32 v[10:11], v[10:11], v[88:89], v[88:89] neg_lo:[1,0,0] neg_hi:[1,0,0]
v_pk_fma_f32 v[12:13], v[12:13], v[90:91], v[90:91] neg_lo:[1,0,0] neg_hi:[1,0,0]
v_pk_fma_f32 v[14:15], v[14:15], v[92:93], v[92:93] neg_lo:[1,0,0] neg_hi:[1,0,0]
v_pk_fma_f32 v[16:17], v[16:17], v[94:95], v[94:95] neg_lo:[1,0,0] neg_hi:[1,0,0]
v_cvt_pk_bf16_f32 v24, v10, v11
v_cvt_pk_bf16_f32 v25, v12, v13
v_cvt_pk_bf16_f32 v26, v14, v15
v_cvt_pk_bf16_f32 v27, v16, v17
ds_write_b64 v28, v[24:25] offset:3072
ds_write_b64 v29, v[26:27] offset:3072
ds_read_b128 v[36:39], v18 offset:3072
v_pk_mul_f32 v[10:11], v[104:105], s[36:37]
v_pk_mul_f32 v[12:13], v[106:107], s[36:37]
v_pk_mul_f32 v[14:15], v[108:109], s[36:37]
v_pk_mul_f32 v[16:17], v[110:111], s[36:37]
v_pk_mul_f32 v[112:113], v[112:113], s[38:39]
v_pk_mul_f32 v[114:115], v[114:115], s[38:39]
v_pk_mul_f32 v[116:117], v[116:117], s[38:39]
v_pk_mul_f32 v[118:119], v[118:119], s[38:39]
v_exp_f32 v10, -|v10|
v_exp_f32 v11, -|v11|
v_exp_f32 v12, -|v12|
v_exp_f32 v13, -|v13|
v_exp_f32 v14, -|v14|
v_exp_f32 v15, -|v15|
v_exp_f32 v16, -|v16|
v_exp_f32 v17, -|v17|
s_mov_b32 s43, 4096
s_waitcnt lgkmcnt(0)
buffer_store_dwordx4 v[36:39], v8, s[20:23], s43 offen offset:2048 nt
v_exp_f32 v112, v112
v_exp_f32 v113, v113
v_exp_f32 v114, v114
v_exp_f32 v115, v115
v_exp_f32 v116, v116
v_exp_f32 v117, v117
v_exp_f32 v118, v118
v_exp_f32 v119, v119
v_bfi_b32 v104, s42, 1.0, v104
v_bfi_b32 v105, s42, 1.0, v105
v_bfi_b32 v106, s42, 1.0, v106
v_bfi_b32 v107, s42, 1.0, v107
v_bfi_b32 v108, s42, 1.0, v108
v_bfi_b32 v109, s42, 1.0, v109
v_bfi_b32 v110, s42, 1.0, v110
v_bfi_b32 v111, s42, 1.0, v111
v_pk_fma_f32 v[104:105], v[10:11], v[104:105], v[104:105]
v_pk_fma_f32 v[106:107], v[12:13], v[106:107], v[106:107]
v_pk_fma_f32 v[108:109], v[14:15], v[108:109], v[108:109]
v_pk_fma_f32 v[110:111], v[16:17], v[110:111], v[110:111]
v_pk_fma_f32 v[104:105], v[112:113], v[104:105], v[104:105]
v_pk_fma_f32 v[106:107], v[114:115], v[106:107], v[106:107]
v_pk_fma_f32 v[108:109], v[116:117], v[108:109], v[108:109]
v_pk_fma_f32 v[110:111], v[118:119], v[110:111], v[110:111]
v_rcp_f32 v104, v104
v_rcp_f32 v105, v105
v_rcp_f32 v106, v106
v_rcp_f32 v107, v107
v_rcp_f32 v108, v108
v_rcp_f32 v109, v109
v_rcp_f32 v110, v110
v_rcp_f32 v111, v111
v_pk_fma_f32 v[10:11], v[10:11], v[104:105], v[104:105] neg_lo:[1,0,0] neg_hi:[1,0,0]
v_pk_fma_f32 v[12:13], v[12:13], v[106:107], v[106:107] neg_lo:[1,0,0] neg_hi:[1,0,0]
v_pk_fma_f32 v[14:15], v[14:15], v[108:109], v[108:109] neg_lo:[1,0,0] neg_hi:[1,0,0]
v_pk_fma_f32 v[16:17], v[16:17], v[110:111], v[110:111] neg_lo:[1,0,0] neg_hi:[1,0,0]
v_cvt_pk_bf16_f32 v20, v10, v11
v_cvt_pk_bf16_f32 v21, v12, v13
v_cvt_pk_bf16_f32 v22, v14, v15
v_cvt_pk_bf16_f32 v23, v16, v17
ds_write_b64 v28, v[20:21] offset:4096
ds_write_b64 v29, v[22:23] offset:4096
ds_read_b128 v[32:35], v18 offset:4096
v_pk_mul_f32 v[10:11], v[120:121], s[36:37]
v_pk_mul_f32 v[12:13], v[122:123], s[36:37]
v_pk_mul_f32 v[14:15], v[124:125], s[36:37]
v_pk_mul_f32 v[16:17], v[126:127], s[36:37]
v_pk_mul_f32 v[128:129], v[128:129], s[38:39]
v_pk_mul_f32 v[130:131], v[130:131], s[38:39]
v_pk_mul_f32 v[132:133], v[132:133], s[38:39]
v_pk_mul_f32 v[134:135], v[134:135], s[38:39]
v_exp_f32 v10, -|v10|
v_exp_f32 v11, -|v11|
v_exp_f32 v12, -|v12|
v_exp_f32 v13, -|v13|
v_exp_f32 v14, -|v14|
v_exp_f32 v15, -|v15|
v_exp_f32 v16, -|v16|
v_exp_f32 v17, -|v17|
s_mov_b32 s43, 8192
s_waitcnt lgkmcnt(0)
buffer_store_dwordx4 v[32:35], v8, s[20:23], s43 offen offset:0 nt
v_exp_f32 v128, v128
v_exp_f32 v129, v129
v_exp_f32 v130, v130
v_exp_f32 v131, v131
v_exp_f32 v132, v132
v_exp_f32 v133, v133
v_exp_f32 v134, v134
v_exp_f32 v135, v135
v_bfi_b32 v120, s42, 1.0, v120
v_bfi_b32 v121, s42, 1.0, v121
v_bfi_b32 v122, s42, 1.0, v122
v_bfi_b32 v123, s42, 1.0, v123
v_bfi_b32 v124, s42, 1.0, v124
v_bfi_b32 v125, s42, 1.0, v125
v_bfi_b32 v126, s42, 1.0, v126
v_bfi_b32 v127, s42, 1.0, v127
v_pk_fma_f32 v[120:121], v[10:11], v[120:121], v[120:121]
v_pk_fma_f32 v[122:123], v[12:13], v[122:123], v[122:123]
v_pk_fma_f32 v[124:125], v[14:15], v[124:125], v[124:125]
v_pk_fma_f32 v[126:127], v[16:17], v[126:127], v[126:127]
v_pk_fma_f32 v[120:121], v[128:129], v[120:121], v[120:121]
v_pk_fma_f32 v[122:123], v[130:131], v[122:123], v[122:123]
v_pk_fma_f32 v[124:125], v[132:133], v[124:125], v[124:125]
v_pk_fma_f32 v[126:127], v[134:135], v[126:127], v[126:127]
v_rcp_f32 v120, v120
v_rcp_f32 v121, v121
v_rcp_f32 v122, v122
v_rcp_f32 v123, v123
v_rcp_f32 v124, v124
v_rcp_f32 v125, v125
v_rcp_f32 v126, v126
v_rcp_f32 v127, v127
v_pk_fma_f32 v[10:11], v[10:11], v[120:121], v[120:121] neg_lo:[1,0,0] neg_hi:[1,0,0]
v_pk_fma_f32 v[12:13], v[12:13], v[122:123], v[122:123] neg_lo:[1,0,0] neg_hi:[1,0,0]
v_pk_fma_f32 v[14:15], v[14:15], v[124:125], v[124:125] neg_lo:[1,0,0] neg_hi:[1,0,0]
v_pk_fma_f32 v[16:17], v[16:17], v[126:127], v[126:127] neg_lo:[1,0,0] neg_hi:[1,0,0]
v_cvt_pk_bf16_f32 v24, v10, v11
v_cvt_pk_bf16_f32 v25, v12, v13
v_cvt_pk_bf16_f32 v26, v14, v15
v_cvt_pk_bf16_f32 v27, v16, v17
ds_write_b64 v28, v[24:25] offset:5120
ds_write_b64 v29, v[26:27] offset:5120
ds_read_b128 v[36:39], v18 offset:5120
v_pk_mul_f32 v[10:11], v[136:137], s[36:37]
v_pk_mul_f32 v[12:13], v[138:139], s[36:37]
v_pk_mul_f32 v[14:15], v[140:141], s[36:37]
v_pk_mul_f32 v[16:17], v[142:143], s[36:37]
v_pk_mul_f32 v[144:145], v[144:145], s[38:39]
v_pk_mul_f32 v[146:147], v[146:147], s[38:39]
v_pk_mul_f32 v[148:149], v[148:149], s[38:39]
v_pk_mul_f32 v[150:151], v[150:151], s[38:39]
v_exp_f32 v10, -|v10|
v_exp_f32 v11, -|v11|
v_exp_f32 v12, -|v12|
v_exp_f32 v13, -|v13|
v_exp_f32 v14, -|v14|
v_exp_f32 v15, -|v15|
v_exp_f32 v16, -|v16|
v_exp_f32 v17, -|v17|
s_mov_b32 s43, 8192
s_waitcnt lgkmcnt(0)
buffer_store_dwordx4 v[36:39], v8, s[20:23], s43 offen offset:2048 nt
v_exp_f32 v144, v144
v_exp_f32 v145, v145
v_exp_f32 v146, v146
v_exp_f32 v147, v147
v_exp_f32 v148, v148
v_exp_f32 v149, v149
v_exp_f32 v150, v150
v_exp_f32 v151, v151
v_bfi_b32 v136, s42, 1.0, v136
v_bfi_b32 v137, s42, 1.0, v137
v_bfi_b32 v138, s42, 1.0, v138
v_bfi_b32 v139, s42, 1.0, v139
v_bfi_b32 v140, s42, 1.0, v140
v_bfi_b32 v141, s42, 1.0, v141
v_bfi_b32 v142, s42, 1.0, v142
v_bfi_b32 v143, s42, 1.0, v143
v_pk_fma_f32 v[136:137], v[10:11], v[136:137], v[136:137]
v_pk_fma_f32 v[138:139], v[12:13], v[138:139], v[138:139]
v_pk_fma_f32 v[140:141], v[14:15], v[140:141], v[140:141]
v_pk_fma_f32 v[142:143], v[16:17], v[142:143], v[142:143]
v_pk_fma_f32 v[136:137], v[144:145], v[136:137], v[136:137]
v_pk_fma_f32 v[138:139], v[146:147], v[138:139], v[138:139]
v_pk_fma_f32 v[140:141], v[148:149], v[140:141], v[140:141]
v_pk_fma_f32 v[142:143], v[150:151], v[142:143], v[142:143]
v_rcp_f32 v136, v136
v_rcp_f32 v137, v137
v_rcp_f32 v138, v138
v_rcp_f32 v139, v139
v_rcp_f32 v140, v140
v_rcp_f32 v141, v141
v_rcp_f32 v142, v142
v_rcp_f32 v143, v143
v_pk_fma_f32 v[10:11], v[10:11], v[136:137], v[136:137] neg_lo:[1,0,0] neg_hi:[1,0,0]
v_pk_fma_f32 v[12:13], v[12:13], v[138:139], v[138:139] neg_lo:[1,0,0] neg_hi:[1,0,0]
v_pk_fma_f32 v[14:15], v[14:15], v[140:141], v[140:141] neg_lo:[1,0,0] neg_hi:[1,0,0]
v_pk_fma_f32 v[16:17], v[16:17], v[142:143], v[142:143] neg_lo:[1,0,0] neg_hi:[1,0,0]
v_cvt_pk_bf16_f32 v20, v10, v11
v_cvt_pk_bf16_f32 v21, v12, v13
v_cvt_pk_bf16_f32 v22, v14, v15
v_cvt_pk_bf16_f32 v23, v16, v17
ds_write_b64 v28, v[20:21] offset:6144
ds_write_b64 v29, v[22:23] offset:6144
ds_read_b128 v[32:35], v18 offset:6144
v_pk_mul_f32 v[10:11], v[152:153], s[36:37]
v_pk_mul_f32 v[12:13], v[154:155], s[36:37]
v_pk_mul_f32 v[14:15], v[156:157], s[36:37]
v_pk_mul_f32 v[16:17], v[158:159], s[36:37]
v_pk_mul_f32 v[160:161], v[160:161], s[38:39]
v_pk_mul_f32 v[162:163], v[162:163], s[38:39]
v_pk_mul_f32 v[164:165], v[164:165], s[38:39]
v_pk_mul_f32 v[166:167], v[166:167], s[38:39]
v_exp_f32 v10, -|v10|
v_exp_f32 v11, -|v11|
v_exp_f32 v12, -|v12|
v_exp_f32 v13, -|v13|
v_exp_f32 v14, -|v14|
v_exp_f32 v15, -|v15|
v_exp_f32 v16, -|v16|
v_exp_f32 v17, -|v17|
s_mov_b32 s43, 12288
s_waitcnt lgkmcnt(0)
buffer_store_dwordx4 v[32:35], v8, s[20:23], s43 offen offset:0 nt
v_exp_f32 v160, v160
v_exp_f32 v161, v161
v_exp_f32 v162, v162
v_exp_f32 v163, v163
v_exp_f32 v164, v164
v_exp_f32 v165, v165
v_exp_f32 v166, v166
v_exp_f32 v167, v167
v_bfi_b32 v152, s42, 1.0, v152
v_bfi_b32 v153, s42, 1.0, v153
v_bfi_b32 v154, s42, 1.0, v154
v_bfi_b32 v155, s42, 1.0, v155
v_bfi_b32 v156, s42, 1.0, v156
v_bfi_b32 v157, s42, 1.0, v157
v_bfi_b32 v158, s42, 1.0, v158
v_bfi_b32 v159, s42, 1.0, v159
v_pk_fma_f32 v[152:153], v[10:11], v[152:153], v[152:153]
v_pk_fma_f32 v[154:155], v[12:13], v[154:155], v[154:155]
v_pk_fma_f32 v[156:157], v[14:15], v[156:157], v[156:157]
v_pk_fma_f32 v[158:159], v[16:17], v[158:159], v[158:159]
v_pk_fma_f32 v[152:153], v[160:161], v[152:153], v[152:153]
v_pk_fma_f32 v[154:155], v[162:163], v[154:155], v[154:155]
v_pk_fma_f32 v[156:157], v[164:165], v[156:157], v[156:157]
v_pk_fma_f32 v[158:159], v[166:167], v[158:159], v[158:159]
v_rcp_f32 v152, v152
v_rcp_f32 v153, v153
v_rcp_f32 v154, v154
v_rcp_f32 v155, v155
v_rcp_f32 v156, v156
v_rcp_f32 v157, v157
v_rcp_f32 v158, v158
v_rcp_f32 v159, v159
v_pk_fma_f32 v[10:11], v[10:11], v[152:153], v[152:153] neg_lo:[1,0,0] neg_hi:[1,0,0]
v_pk_fma_f32 v[12:13], v[12:13], v[154:155], v[154:155] neg_lo:[1,0,0] neg_hi:[1,0,0]
v_pk_fma_f32 v[14:15], v[14:15], v[156:157], v[156:157] neg_lo:[1,0,0] neg_hi:[1,0,0]
v_pk_fma_f32 v[16:17], v[16:17], v[158:159], v[158:159] neg_lo:[1,0,0] neg_hi:[1,0,0]
v_cvt_pk_bf16_f32 v24, v10, v11
v_cvt_pk_bf16_f32 v25, v12, v13
v_cvt_pk_bf16_f32 v26, v14, v15
v_cvt_pk_bf16_f32 v27, v16, v17
ds_write_b64 v28, v[24:25] offset:7168
ds_write_b64 v29, v[26:27] offset:7168
ds_read_b128 v[36:39], v18 offset:7168
s_mov_b32 s43, 12288
s_waitcnt lgkmcnt(0)
buffer_store_dwordx4 v[36:39], v8, s[20:23], s43 offen offset:2048 nt
s_endpgm
L_codeend:
.section .rodata,"a"
.p2align 6
.amdhsa_kernel standalone__autoregressive_conv_wavernn__speech_kernel
  .amdhsa_next_free_vgpr 256
  .amdhsa_next_free_sgpr 96
  .amdhsa_accum_offset 168
  .amdhsa_group_segment_fixed_size 0
  .amdhsa_kernarg_size 40
  .amdhsa_user_sgpr_count 2
  .amdhsa_user_sgpr_kernarg_segment_ptr 1
  .amdhsa_system_sgpr_workgroup_id_x 1
  .amdhsa_float_denorm_mode_32 3
.end_amdhsa_kernel
```
